```python
import torch

def _softmax(x, axis=-1):
    return torch.softmax(x, dim=axis)
def _gelu(x):
    return torch.nn.functional.gelu(x, approximate="tanh")
def _silu(x):
    return torch.nn.functional.silu(x)
def _sigmoid(x):
    return torch.sigmoid(x)
def _layernorm(x, axis=-1, eps=1e-5):
    m = x.mean(dim=axis, keepdim=True)
    v = x.var(dim=axis, keepdim=True, unbiased=False)
    return (x - m) / torch.sqrt(v + eps)
def _scatter_add(tgt, idx, src, axis=0):
    return tgt.clone().index_add_(axis, idx, src)
def _segment_sum(src, seg, n):
    out = torch.zeros((n,) + src.shape[1:], dtype=src.dtype)
    return out.index_add_(0, seg, src)
def _pad(x, pw):
    flat = tuple(v for pair in reversed(pw) for v in pair)
    return torch.nn.functional.pad(x, flat)

kernel_name = 'standalone__ssm_conv_s5__prompt'

def setup_inputs():

    _w = (lambda a: (lambda t: t.to(torch.bfloat16) if t.is_floating_point() else t)(torch.as_tensor(a)))
    B, S, D = 1, 2048, 1024
    P = D
    Lambda_re = -0.5 * (lambda _x: torch.exp(torch.as_tensor(_x)))((lambda *s: torch.randn(*s, dtype=torch.bfloat16) * 0.2)(P))
    Lambda_im = (lambda *s: torch.randn(*s, dtype=torch.bfloat16) * 0.4)(P) * 1.0
    B_re = (lambda *s: torch.randn(*s, dtype=torch.bfloat16) * 0.2)(P, D) * (D ** -0.5)
    B_im = (lambda *s: torch.randn(*s, dtype=torch.bfloat16) * 0.2)(P, D) * (D ** -0.5)
    C_re = (lambda *s: torch.randn(*s, dtype=torch.bfloat16) * 0.2)(D, P) * (P ** -0.5)
    C_im = (lambda *s: torch.randn(*s, dtype=torch.bfloat16) * 0.2)(D, P) * (P ** -0.5)
    log_dt = (lambda *s: torch.randn(*s, dtype=torch.bfloat16) * 0.2)(P) * 0.3 - 2.0
    Dskip = (lambda *s: torch.randn(*s, dtype=torch.bfloat16) * 0.05)(D)
    return {
        "x": _w((lambda *s: torch.randn(*s, dtype=torch.bfloat16) * 0.05)(B, S, D)),
        "Lambda_re": _w(Lambda_re),
        "Lambda_im": _w(Lambda_im),
        "B_re": _w(B_re),
        "B_im": _w(B_im),
        "C_re": _w(C_re),
        "C_im": _w(C_im),
        "log_dt": _w(log_dt),
        "Dskip": _w(Dskip),
    }

def reference(x, Lambda_re, Lambda_im, B_re, B_im, C_re, C_im, log_dt, Dskip):
    Bsz, L, H = x.shape
    Lam = Lambda_re + 1j * Lambda_im
    Bmat = B_re + 1j * B_im
    Cmat = C_re + 1j * C_im
    dt = torch.exp(log_dt)
    Lam_bar = torch.exp(dt * Lam)
    B_bar = ((Lam_bar - 1.0) / Lam)[:, None] * Bmat
    Bu = torch.einsum("bld,pd->blp", x + 0j, B_bar)
    h = torch.zeros_like(Bu[:, 0, :])
    hs = []
    for t in range(L):
        h = Lam_bar[None, :] * h + Bu[:, t, :]
        hs.append(h)
    hseq = torch.stack(hs, 1)
    y = 2.0 * torch.einsum("blp,dp->bld", hseq, Cmat).real + x * Dskip[None, None, :]
    return y
```

```asm
; @launch grid=(256,1,1) block=(512,1,1) lds=163840
.amdgcn_target "amdgcn-amd-amdhsa--gfx950"
.text
.globl standalone__ssm_conv_s5__prompt_kernel
.p2align 8
.type standalone__ssm_conv_s5__prompt_kernel,@function
standalone__ssm_conv_s5__prompt_kernel:
    s_cmp_ge_u32 s2, 256
    s_cbranch_scc1 KF_done
    s_load_dwordx4 s[4:7], s[0:1], 0
    s_load_dwordx4 s[8:11], s[0:1], 16
    s_load_dwordx2 s[12:13], s[0:1], 32
    s_load_dwordx2 s[14:15], s[0:1], 56
    s_load_dwordx4 s[16:19], s[0:1], 80
    s_load_dwordx4 s[84:87], s[0:1], 40
    s_load_dwordx4 s[88:91], s[0:1], 64
    s_and_b32 s3, s2, 7
    s_lshr_b32 s60, s2, 3
    s_lshr_b32 s52, s3, 1
    s_lshl_b32 s52, s52, 2
    s_lshr_b32 s53, s60, 3
    s_add_u32 s40, s52, s53
    s_and_b32 s52, s3, 1
    s_lshl_b32 s52, s52, 3
    s_and_b32 s53, s60, 7
    s_add_u32 s41, s52, s53
    s_and_b32 s60, s60, 15
    v_and_b32 v1, 63, v0
    v_lshrrev_b32 v30, 6, v0
    s_nop 0
    v_readfirstlane_b32 s42, v30
    v_and_b32 v2, 31, v0
    v_lshrrev_b32 v3, 5, v1
    v_lshrrev_b32 v192, 3, v1
    v_and_b32 v192, 3, v192
    v_lshl_add_u32 v192, v3, 4, v192
    v_lshrrev_b32 v193, 4, v1
    v_and_b32 v194, 7, v1
    v_xor_b32 v193, v193, v194
    s_lshr_b32 s43, s42, 2
    s_lshr_b32 s44, s42, 1
    s_and_b32 s44, s44, 1
    s_and_b32 s45, s42, 1
    s_lshl_b32 s46, s44, 1
    s_add_u32 s46, s46, s43
    s_lshl_b32 s46, s46, 1
    s_lshl_b32 s52, s42, 1
    s_add_u32 s52, s52, 0
    s_lshr_b32 s53, s52, 2
    s_lshl_b32 s53, s53, 5
    s_and_b32 s52, s52, 3
    s_lshl_b32 s52, s52, 2
    s_add_u32 s52, s52, s53
    s_lshl_b32 s53, s40, 7
    s_add_u32 s52, s52, s53
    v_add_u32 v4, s52, v192
    v_lshlrev_b32 v4, 11, v4
    v_xor_b32 v194, 0, v193
    v_lshl_add_u32 v4, v194, 4, v4
    s_lshl_b32 s52, s41, 6
    s_lshl_b32 s53, s43, 5
    s_add_u32 s52, s52, s53
    s_lshl_b32 s53, s45, 4
    s_add_u32 s52, s52, s53
    s_add_u32 s52, s52, 0
    v_lshrrev_b32 v6, 3, v1
    v_add_u32 v6, s52, v6
    v_lshlrev_b32 v6, 11, v6
    v_lshl_add_u32 v6, v194, 4, v6
    s_lshl_b32 s52, s42, 1
    s_add_u32 s52, s52, 1
    s_lshr_b32 s53, s52, 2
    s_lshl_b32 s53, s53, 5
    s_and_b32 s52, s52, 3
    s_lshl_b32 s52, s52, 2
    s_add_u32 s52, s52, s53
    s_lshl_b32 s53, s40, 7
    s_add_u32 s52, s52, s53
    v_add_u32 v5, s52, v192
    v_lshlrev_b32 v5, 11, v5
    v_xor_b32 v194, 4, v193
    v_lshl_add_u32 v5, v194, 4, v5
    s_lshl_b32 s52, s41, 6
    s_lshl_b32 s53, s43, 5
    s_add_u32 s52, s52, s53
    s_lshl_b32 s53, s45, 4
    s_add_u32 s52, s52, s53
    s_add_u32 s52, s52, 8
    v_lshrrev_b32 v7, 3, v1
    v_add_u32 v7, s52, v7
    v_lshlrev_b32 v7, 11, v7
    v_lshl_add_u32 v7, v194, 4, v7
    s_lshl_b32 s48, s42, 11
    s_add_u32 s49, s48, 16384
    s_waitcnt lgkmcnt(0)
    s_mov_b32 s20, s4
    s_and_b32 s21, s5, 0xffff
    s_mov_b32 s22, 4194304
    s_mov_b32 s23, 0x00020000
    s_cmp_eq_u32 s44, 0
    s_cselect_b32 s52, s10, s12
    s_cselect_b32 s53, s11, s13
    s_mov_b32 s24, s52
    s_and_b32 s25, s53, 0xffff
    s_mov_b32 s26, 2097152
    s_mov_b32 s27, 0x00020000
    s_lshl_b32 s52, s41, 6
    s_lshl_b32 s53, s45, 5
    s_add_u32 s53, s53, s52
    v_add_u32 v42, s53, v2
    v_add_u32 v60, s52, v1
    v_lshlrev_b32 v33, 1, v42
    global_load_ushort v30, v33, s[6:7]
    global_load_ushort v31, v33, s[8:9]
    global_load_ushort v32, v33, s[14:15]
    v_lshlrev_b32 v51, 1, v60
    global_load_ushort v48, v51, s[6:7]
    global_load_ushort v49, v51, s[8:9]
    global_load_ushort v50, v51, s[14:15]
    s_add_u32 s47, s60, 0
    s_and_b32 s47, s47, 15
    s_lshl_b32 s47, s47, 7
    s_add_u32 m0, s48, 0
    s_nop 0
    buffer_load_dwordx4 v4, s[20:23], s47 offen lds
    s_add_u32 m0, s48, 1024
    s_nop 0
    buffer_load_dwordx4 v5, s[20:23], s47 offen lds
    s_add_u32 m0, s49, 0
    s_nop 0
    buffer_load_dwordx4 v6, s[24:27], s47 offen lds
    s_add_u32 m0, s49, 1024
    s_nop 0
    buffer_load_dwordx4 v7, s[24:27], s47 offen lds
    s_add_u32 s47, s60, 1
    s_and_b32 s47, s47, 15
    s_lshl_b32 s47, s47, 7
    s_add_u32 m0, s48, 32768
    s_nop 0
    buffer_load_dwordx4 v4, s[20:23], s47 offen lds
    s_add_u32 m0, s48, 33792
    s_nop 0
    buffer_load_dwordx4 v5, s[20:23], s47 offen lds
    s_add_u32 m0, s49, 32768
    s_nop 0
    buffer_load_dwordx4 v6, s[24:27], s47 offen lds
    s_add_u32 m0, s49, 33792
    s_nop 0
    buffer_load_dwordx4 v7, s[24:27], s47 offen lds
    s_add_u32 s47, s60, 2
    s_and_b32 s47, s47, 15
    s_lshl_b32 s47, s47, 7
    s_add_u32 m0, s48, 65536
    s_nop 0
    buffer_load_dwordx4 v4, s[20:23], s47 offen lds
    s_add_u32 m0, s48, 66560
    s_nop 0
    buffer_load_dwordx4 v5, s[20:23], s47 offen lds
    s_add_u32 m0, s49, 65536
    s_nop 0
    buffer_load_dwordx4 v6, s[24:27], s47 offen lds
    s_add_u32 m0, s49, 66560
    s_nop 0
    buffer_load_dwordx4 v7, s[24:27], s47 offen lds
    s_add_u32 s47, s60, 3
    s_and_b32 s47, s47, 15
    s_lshl_b32 s47, s47, 7
    s_add_u32 m0, s48, 98304
    s_nop 0
    buffer_load_dwordx4 v4, s[20:23], s47 offen lds
    s_add_u32 m0, s48, 99328
    s_nop 0
    buffer_load_dwordx4 v5, s[20:23], s47 offen lds
    s_add_u32 m0, s49, 98304
    s_nop 0
    buffer_load_dwordx4 v6, s[24:27], s47 offen lds
    s_add_u32 m0, s49, 99328
    s_nop 0
    buffer_load_dwordx4 v7, s[24:27], s47 offen lds
    s_mov_b32 s28, s18
    s_and_b32 s29, s19, 0xffff
    s_mov_b32 s30, 8527872
    s_mov_b32 s31, 0x00020000
    s_mov_b32 s32, s16
    s_and_b32 s33, s17, 0xffff
    s_mov_b32 s34, 256
    s_mov_b32 s35, 0x00020000
    s_lshl_b32 s52, s40, 4
    s_add_u32 s54, s52, s41
    s_lshl_b32 s52, s54, 9
    s_add_u32 s52, s52, 8388608
    s_lshl_b32 s53, s42, 6
    s_add_u32 s52, s52, s53
    v_lshlrev_b32 v195, 2, v1
    v_add_u32 v195, s52, v195
    v_mov_b32 v196, -1
    s_lshl_b32 s52, s54, 3
    s_add_u32 s52, s52, s42
    s_lshl_b32 s52, s52, 2
    s_add_u32 s58, s52, 8519680
    s_mov_b64 exec, 0x10000
    v_mov_b32 v195, s58
    s_mov_b64 exec, 0x1ffff
    buffer_store_dword v196, v195, s[28:31], 0 offen sc1
    s_mov_b64 exec, -1
    v_lshrrev_b32 v192, 1, v2
    v_and_b32 v192, 7, v192
    v_xor_b32 v192, v192, v3
    s_lshl_b32 s52, s43, 2
    s_add_u32 s53, s52, 0
    v_xor_b32 v193, s53, v192
    v_lshlrev_b32 v193, 4, v193
    v_lshl_add_u32 v193, v2, 7, v193
    s_lshl_b32 s53, s44, 13
    v_add_u32 v8, s53, v193
    s_lshl_b32 s53, s45, 13
    s_add_u32 s53, s53, 16384
    v_add_u32 v10, s53, v193
    s_add_u32 s53, s52, 2
    v_xor_b32 v193, s53, v192
    v_lshlrev_b32 v193, 4, v193
    v_lshl_add_u32 v193, v2, 7, v193
    s_lshl_b32 s53, s44, 13
    v_add_u32 v9, s53, v193
    s_lshl_b32 s53, s45, 13
    s_add_u32 s53, s53, 16384
    v_add_u32 v11, s53, v193
    v_mov_b32 v96, 0
    v_mov_b32 v97, 0
    v_mov_b32 v98, 0
    v_mov_b32 v99, 0
    v_mov_b32 v100, 0
    v_mov_b32 v101, 0
    v_mov_b32 v102, 0
    v_mov_b32 v103, 0
    v_mov_b32 v104, 0
    v_mov_b32 v105, 0
    v_mov_b32 v106, 0
    v_mov_b32 v107, 0
    v_mov_b32 v108, 0
    v_mov_b32 v109, 0
    v_mov_b32 v110, 0
    v_mov_b32 v111, 0
    v_mov_b32 v112, 0
    v_mov_b32 v113, 0
    v_mov_b32 v114, 0
    v_mov_b32 v115, 0
    v_mov_b32 v116, 0
    v_mov_b32 v117, 0
    v_mov_b32 v118, 0
    v_mov_b32 v119, 0
    v_mov_b32 v120, 0
    v_mov_b32 v121, 0
    v_mov_b32 v122, 0
    v_mov_b32 v123, 0
    v_mov_b32 v124, 0
    v_mov_b32 v125, 0
    v_mov_b32 v126, 0
    v_mov_b32 v127, 0
    v_mov_b32 v128, 0
    v_mov_b32 v129, 0
    v_mov_b32 v130, 0
    v_mov_b32 v131, 0
    v_mov_b32 v132, 0
    v_mov_b32 v133, 0
    v_mov_b32 v134, 0
    v_mov_b32 v135, 0
    v_mov_b32 v136, 0
    v_mov_b32 v137, 0
    v_mov_b32 v138, 0
    v_mov_b32 v139, 0
    v_mov_b32 v140, 0
    v_mov_b32 v141, 0
    v_mov_b32 v142, 0
    v_mov_b32 v143, 0
    v_mov_b32 v144, 0
    v_mov_b32 v145, 0
    v_mov_b32 v146, 0
    v_mov_b32 v147, 0
    v_mov_b32 v148, 0
    v_mov_b32 v149, 0
    v_mov_b32 v150, 0
    v_mov_b32 v151, 0
    v_mov_b32 v152, 0
    v_mov_b32 v153, 0
    v_mov_b32 v154, 0
    v_mov_b32 v155, 0
    v_mov_b32 v156, 0
    v_mov_b32 v157, 0
    v_mov_b32 v158, 0
    v_mov_b32 v159, 0
    s_waitcnt vmcnt(17)
    v_lshlrev_b32 v30, 16, v30
    v_lshlrev_b32 v31, 16, v31
    v_lshlrev_b32 v32, 16, v32
    v_mul_f32 v33, 0x3fb8aa3b, v32
    v_exp_f32 v33, v33
    s_nop 0
    v_cvt_pk_bf16_f32 v33, v33, v33
    v_lshlrev_b32 v33, 16, v33
    v_mul_f32 v34, v33, v30
    v_mul_f32 v35, v33, v31
    v_mul_f32 v34, 0x3fb8aa3b, v34
    v_mul_f32 v35, 0x3e22f983, v35
    v_mul_f32 v36, 0x3f800000, v34
    v_mul_f32 v37, 0x3f800000, v35
    v_exp_f32 v36, v36
    v_fract_f32 v37, v37
    v_cos_f32 v38, v37
    v_sin_f32 v37, v37
    s_nop 0
    v_mul_f32 v20, v36, v38
    v_mul_f32 v21, v36, v37
    v_add_f32 v36, -1.0, v20
    v_mul_f32 v37, v30, v30
    v_fma_f32 v37, v31, v31, v37
    v_rcp_f32 v37, v37
    v_mul_f32 v38, v36, v30
    v_fma_f32 v38, v21, v31, v38
    v_mul_f32 v33, v21, v30
    v_fma_f32 v33, -v36, v31, v33
    v_add_f32 v37, v37, v37
    v_mul_f32 v24, v38, v37
    v_mul_f32 v25, v33, v37
    v_mul_f32 v36, 0x41800000, v34
    v_mul_f32 v37, 0x41800000, v35
    v_exp_f32 v36, v36
    v_fract_f32 v37, v37
    v_cos_f32 v38, v37
    v_sin_f32 v37, v37
    s_nop 0
    v_mul_f32 v22, v36, v38
    v_mul_f32 v23, v36, v37
    v_lshlrev_b32 v48, 16, v48
    v_lshlrev_b32 v49, 16, v49
    v_lshlrev_b32 v50, 16, v50
    v_mul_f32 v51, 0x3fb8aa3b, v50
    v_exp_f32 v51, v51
    s_nop 0
    v_cvt_pk_bf16_f32 v51, v51, v51
    v_lshlrev_b32 v51, 16, v51
    v_mul_f32 v52, v51, v48
    v_mul_f32 v53, v51, v49
    v_mul_f32 v52, 0x3fb8aa3b, v52
    v_mul_f32 v53, 0x3e22f983, v53
    v_mul_f32 v54, 0x41800000, v52
    v_mul_f32 v55, 0x41800000, v53
    v_exp_f32 v54, v54
    v_fract_f32 v55, v55
    v_cos_f32 v56, v55
    v_sin_f32 v55, v55
    s_nop 0
    v_mul_f32 v26, v54, v56
    v_mul_f32 v27, v54, v55
    v_mul_f32 v54, 0x43000000, v52
    v_mul_f32 v55, 0x43000000, v53
    v_exp_f32 v54, v54
    v_fract_f32 v55, v55
    v_cos_f32 v56, v55
    v_sin_f32 v55, v55
    s_nop 0
    v_mul_f32 v28, v54, v56
    v_mul_f32 v29, v54, v55
    s_waitcnt vmcnt(9)
    s_barrier
    ds_read_b128 v[64:67], v8 offset:0
    ds_read_b128 v[68:71], v8 offset:4096
    ds_read_b128 v[72:75], v10 offset:0
    ds_read_b128 v[76:79], v10 offset:4096
    s_mov_b32 s36, 0
    s_mov_b32 s37, 0
    s_mov_b32 s38, 32768
    s_mov_b32 s39, 131072
    v_add_u32 v14, s37, v9
    v_add_u32 v15, s37, v11
    v_add_u32 v12, s38, v8
    v_add_u32 v13, s38, v10
    s_add_u32 s47, s60, 4
    s_and_b32 s47, s47, 15
    s_lshl_b32 s47, s47, 7
    s_waitcnt lgkmcnt(0)
    v_mfma_f32_32x32x16_bf16 v[96:111], v[64:67], v[72:75], v[96:111]
    ds_read_b128 v[80:83], v14 offset:0
    ds_read_b128 v[84:87], v14 offset:4096
    v_mfma_f32_32x32x16_bf16 v[112:127], v[64:67], v[76:79], v[112:127]
    ds_read_b128 v[88:91], v15 offset:0
    ds_read_b128 v[92:95], v15 offset:4096
    s_add_u32 s61, s48, s39
    s_add_u32 m0, s61, 0
    s_nop 0
    buffer_load_dwordx4 v4, s[20:23], s47 offen lds
    v_mfma_f32_32x32x16_bf16 v[128:143], v[68:71], v[72:75], v[128:143]
    s_add_u32 s61, s48, s39
    s_add_u32 m0, s61, 1024
    s_nop 0
    buffer_load_dwordx4 v5, s[20:23], s47 offen lds
    v_mfma_f32_32x32x16_bf16 v[144:159], v[68:71], v[76:79], v[144:159]
    ds_read_b128 v[64:67], v12 offset:0
    ds_read_b128 v[68:71], v12 offset:4096
    ds_read_b128 v[72:75], v13 offset:0
    ds_read_b128 v[76:79], v13 offset:4096
    s_waitcnt lgkmcnt(4)
    v_mfma_f32_32x32x16_bf16 v[96:111], v[80:83], v[88:91], v[96:111]
    s_add_u32 s61, s49, s39
    s_add_u32 m0, s61, 0
    s_nop 0
    buffer_load_dwordx4 v6, s[24:27], s47 offen lds
    v_mfma_f32_32x32x16_bf16 v[112:127], v[80:83], v[92:95], v[112:127]
    s_add_u32 s61, s49, s39
    s_add_u32 m0, s61, 1024
    s_nop 0
    buffer_load_dwordx4 v7, s[24:27], s47 offen lds
    v_mfma_f32_32x32x16_bf16 v[128:143], v[84:87], v[88:91], v[128:143]
    s_mov_b32 s39, s37
    s_mov_b32 s37, s38
    s_add_u32 s38, s38, 32768
    s_cmp_ge_u32 s38, 163840
    s_cselect_b32 s38, 0, s38
    s_add_u32 s36, s36, 1
    v_add_u32 v14, s37, v9
    v_add_u32 v15, s37, v11
    v_add_u32 v12, s38, v8
    v_add_u32 v13, s38, v10
    s_add_u32 s47, s47, 128
    s_and_b32 s47, s47, 2047
    v_mfma_f32_32x32x16_bf16 v[144:159], v[84:87], v[92:95], v[144:159]
    s_waitcnt vmcnt(8) lgkmcnt(0)
    s_barrier
    v_mfma_f32_32x32x16_bf16 v[96:111], v[64:67], v[72:75], v[96:111]
    ds_read_b128 v[80:83], v14 offset:0
    ds_read_b128 v[84:87], v14 offset:4096
    v_mfma_f32_32x32x16_bf16 v[112:127], v[64:67], v[76:79], v[112:127]
    ds_read_b128 v[88:91], v15 offset:0
    ds_read_b128 v[92:95], v15 offset:4096
    s_add_u32 s61, s48, s39
    s_add_u32 m0, s61, 0
    s_nop 0
    buffer_load_dwordx4 v4, s[20:23], s47 offen lds
    v_mfma_f32_32x32x16_bf16 v[128:143], v[68:71], v[72:75], v[128:143]
    s_add_u32 s61, s48, s39
    s_add_u32 m0, s61, 1024
    s_nop 0
    buffer_load_dwordx4 v5, s[20:23], s47 offen lds
    v_mfma_f32_32x32x16_bf16 v[144:159], v[68:71], v[76:79], v[144:159]
    ds_read_b128 v[64:67], v12 offset:0
    ds_read_b128 v[68:71], v12 offset:4096
    ds_read_b128 v[72:75], v13 offset:0
    ds_read_b128 v[76:79], v13 offset:4096
    s_waitcnt lgkmcnt(4)
    v_mfma_f32_32x32x16_bf16 v[96:111], v[80:83], v[88:91], v[96:111]
    s_add_u32 s61, s49, s39
    s_add_u32 m0, s61, 0
    s_nop 0
    buffer_load_dwordx4 v6, s[24:27], s47 offen lds
    v_mfma_f32_32x32x16_bf16 v[112:127], v[80:83], v[92:95], v[112:127]
    s_add_u32 s61, s49, s39
    s_add_u32 m0, s61, 1024
    s_nop 0
    buffer_load_dwordx4 v7, s[24:27], s47 offen lds
    v_mfma_f32_32x32x16_bf16 v[128:143], v[84:87], v[88:91], v[128:143]
    s_mov_b32 s39, s37
    s_mov_b32 s37, s38
    s_add_u32 s38, s38, 32768
    s_cmp_ge_u32 s38, 163840
    s_cselect_b32 s38, 0, s38
    s_add_u32 s36, s36, 1
    v_add_u32 v14, s37, v9
    v_add_u32 v15, s37, v11
    v_add_u32 v12, s38, v8
    v_add_u32 v13, s38, v10
    s_add_u32 s47, s47, 128
    s_and_b32 s47, s47, 2047
    v_mfma_f32_32x32x16_bf16 v[144:159], v[84:87], v[92:95], v[144:159]
    s_waitcnt vmcnt(8) lgkmcnt(0)
    s_barrier
    s_lshl_b32 s52, 1, s40
    v_mov_b32 v192, s52
    s_lshl_b32 s53, s41, 2
    v_mov_b32 v193, s53
    s_cmp_lg_u32 s42, 0
    s_cbranch_scc1 K1_noflag
    s_mov_b64 exec, 1
    buffer_atomic_or v192, v193, s[32:35], 0 offen sc1
    s_mov_b64 exec, -1
K1_noflag:
K1_loop:
    v_mfma_f32_32x32x16_bf16 v[96:111], v[64:67], v[72:75], v[96:111]
    ds_read_b128 v[80:83], v14 offset:0
    ds_read_b128 v[84:87], v14 offset:4096
    v_mfma_f32_32x32x16_bf16 v[112:127], v[64:67], v[76:79], v[112:127]
    ds_read_b128 v[88:91], v15 offset:0
    ds_read_b128 v[92:95], v15 offset:4096
    s_add_u32 s61, s48, s39
    s_add_u32 m0, s61, 0
    s_nop 0
    buffer_load_dwordx4 v4, s[20:23], s47 offen lds
    v_mfma_f32_32x32x16_bf16 v[128:143], v[68:71], v[72:75], v[128:143]
    s_add_u32 s61, s48, s39
    s_add_u32 m0, s61, 1024
    s_nop 0
    buffer_load_dwordx4 v5, s[20:23], s47 offen lds
    v_mfma_f32_32x32x16_bf16 v[144:159], v[68:71], v[76:79], v[144:159]
    ds_read_b128 v[64:67], v12 offset:0
    ds_read_b128 v[68:71], v12 offset:4096
    ds_read_b128 v[72:75], v13 offset:0
    ds_read_b128 v[76:79], v13 offset:4096
    s_waitcnt lgkmcnt(4)
    v_mfma_f32_32x32x16_bf16 v[96:111], v[80:83], v[88:91], v[96:111]
    s_add_u32 s61, s49, s39
    s_add_u32 m0, s61, 0
    s_nop 0
    buffer_load_dwordx4 v6, s[24:27], s47 offen lds
    v_mfma_f32_32x32x16_bf16 v[112:127], v[80:83], v[92:95], v[112:127]
    s_add_u32 s61, s49, s39
    s_add_u32 m0, s61, 1024
    s_nop 0
    buffer_load_dwordx4 v7, s[24:27], s47 offen lds
    v_mfma_f32_32x32x16_bf16 v[128:143], v[84:87], v[88:91], v[128:143]
    s_mov_b32 s39, s37
    s_mov_b32 s37, s38
    s_add_u32 s38, s38, 32768
    s_cmp_ge_u32 s38, 163840
    s_cselect_b32 s38, 0, s38
    s_add_u32 s36, s36, 1
    v_add_u32 v14, s37, v9
    v_add_u32 v15, s37, v11
    v_add_u32 v12, s38, v8
    v_add_u32 v13, s38, v10
    s_add_u32 s47, s47, 128
    s_and_b32 s47, s47, 2047
    v_mfma_f32_32x32x16_bf16 v[144:159], v[84:87], v[92:95], v[144:159]
    s_waitcnt vmcnt(8) lgkmcnt(0)
    s_cmp_lt_u32 s36, 12
    s_barrier
    s_cbranch_scc1 K1_loop
    v_mfma_f32_32x32x16_bf16 v[96:111], v[64:67], v[72:75], v[96:111]
    ds_read_b128 v[80:83], v14 offset:0
    ds_read_b128 v[84:87], v14 offset:4096
    v_mfma_f32_32x32x16_bf16 v[112:127], v[64:67], v[76:79], v[112:127]
    ds_read_b128 v[88:91], v15 offset:0
    ds_read_b128 v[92:95], v15 offset:4096
    v_mfma_f32_32x32x16_bf16 v[128:143], v[68:71], v[72:75], v[128:143]
    v_mfma_f32_32x32x16_bf16 v[144:159], v[68:71], v[76:79], v[144:159]
    ds_read_b128 v[64:67], v12 offset:0
    ds_read_b128 v[68:71], v12 offset:4096
    ds_read_b128 v[72:75], v13 offset:0
    ds_read_b128 v[76:79], v13 offset:4096
    s_waitcnt lgkmcnt(4)
    v_mfma_f32_32x32x16_bf16 v[96:111], v[80:83], v[88:91], v[96:111]
    v_mfma_f32_32x32x16_bf16 v[112:127], v[80:83], v[92:95], v[112:127]
    v_mfma_f32_32x32x16_bf16 v[128:143], v[84:87], v[88:91], v[128:143]
    s_mov_b32 s39, s37
    s_mov_b32 s37, s38
    s_add_u32 s38, s38, 32768
    s_cmp_ge_u32 s38, 163840
    s_cselect_b32 s38, 0, s38
    s_add_u32 s36, s36, 1
    v_add_u32 v14, s37, v9
    v_add_u32 v15, s37, v11
    v_add_u32 v12, s38, v8
    v_add_u32 v13, s38, v10
    v_mfma_f32_32x32x16_bf16 v[144:159], v[84:87], v[92:95], v[144:159]
    s_waitcnt vmcnt(4) lgkmcnt(0)
    s_barrier
    v_mfma_f32_32x32x16_bf16 v[96:111], v[64:67], v[72:75], v[96:111]
    ds_read_b128 v[80:83], v14 offset:0
    ds_read_b128 v[84:87], v14 offset:4096
    v_mfma_f32_32x32x16_bf16 v[112:127], v[64:67], v[76:79], v[112:127]
    ds_read_b128 v[88:91], v15 offset:0
    ds_read_b128 v[92:95], v15 offset:4096
    v_mfma_f32_32x32x16_bf16 v[128:143], v[68:71], v[72:75], v[128:143]
    v_mfma_f32_32x32x16_bf16 v[144:159], v[68:71], v[76:79], v[144:159]
    ds_read_b128 v[64:67], v12 offset:0
    ds_read_b128 v[68:71], v12 offset:4096
    ds_read_b128 v[72:75], v13 offset:0
    ds_read_b128 v[76:79], v13 offset:4096
    s_waitcnt lgkmcnt(4)
    v_mfma_f32_32x32x16_bf16 v[96:111], v[80:83], v[88:91], v[96:111]
    v_mfma_f32_32x32x16_bf16 v[112:127], v[80:83], v[92:95], v[112:127]
    v_mfma_f32_32x32x16_bf16 v[128:143], v[84:87], v[88:91], v[128:143]
    s_mov_b32 s39, s37
    s_mov_b32 s37, s38
    s_add_u32 s38, s38, 32768
    s_cmp_ge_u32 s38, 163840
    s_cselect_b32 s38, 0, s38
    s_add_u32 s36, s36, 1
    v_add_u32 v14, s37, v9
    v_add_u32 v15, s37, v11
    v_add_u32 v12, s38, v8
    v_add_u32 v13, s38, v10
    v_mfma_f32_32x32x16_bf16 v[144:159], v[84:87], v[92:95], v[144:159]
    s_waitcnt vmcnt(0) lgkmcnt(0)
    s_barrier
    s_cmp_lt_u32 s42, 4
    s_cselect_b32 s54, s84, s86
    s_cselect_b32 s55, s85, s87
    s_and_b32 s52, s40, 3
    s_lshl_b32 s52, s52, 4
    s_and_b32 s53, s42, 3
    s_lshl_b32 s53, s53, 2
    s_add_u32 s52, s52, s53
    s_lshl_b32 s53, s41, 6
    s_add_u32 s52, s52, s53
    v_lshrrev_b32 v192, 4, v1
    v_add_u32 v192, s52, v192
    v_lshlrev_b32 v192, 11, v192
    v_and_b32 v193, 15, v1
    v_lshl_add_u32 v192, v193, 7, v192
    global_load_dword v222, v192, s[54:55]
    v_mfma_f32_32x32x16_bf16 v[96:111], v[64:67], v[72:75], v[96:111]
    ds_read_b128 v[80:83], v14 offset:0
    ds_read_b128 v[84:87], v14 offset:4096
    v_mfma_f32_32x32x16_bf16 v[112:127], v[64:67], v[76:79], v[112:127]
    ds_read_b128 v[88:91], v15 offset:0
    ds_read_b128 v[92:95], v15 offset:4096
    v_mfma_f32_32x32x16_bf16 v[128:143], v[68:71], v[72:75], v[128:143]
    v_mfma_f32_32x32x16_bf16 v[144:159], v[68:71], v[76:79], v[144:159]
    ds_read_b128 v[64:67], v12 offset:0
    ds_read_b128 v[68:71], v12 offset:4096
    ds_read_b128 v[72:75], v13 offset:0
    ds_read_b128 v[76:79], v13 offset:4096
    s_waitcnt lgkmcnt(4)
    v_mfma_f32_32x32x16_bf16 v[96:111], v[80:83], v[88:91], v[96:111]
    v_mfma_f32_32x32x16_bf16 v[112:127], v[80:83], v[92:95], v[112:127]
    v_mfma_f32_32x32x16_bf16 v[128:143], v[84:87], v[88:91], v[128:143]
    s_mov_b32 s39, s37
    s_mov_b32 s37, s38
    s_add_u32 s38, s38, 32768
    s_cmp_ge_u32 s38, 163840
    s_cselect_b32 s38, 0, s38
    s_add_u32 s36, s36, 1
    v_add_u32 v14, s37, v9
    v_add_u32 v15, s37, v11
    v_add_u32 v12, s38, v8
    v_add_u32 v13, s38, v10
    v_mfma_f32_32x32x16_bf16 v[144:159], v[84:87], v[92:95], v[144:159]
    s_waitcnt lgkmcnt(0)
    s_barrier
    v_mfma_f32_32x32x16_bf16 v[96:111], v[64:67], v[72:75], v[96:111]
    ds_read_b128 v[80:83], v14 offset:0
    ds_read_b128 v[84:87], v14 offset:4096
    v_mfma_f32_32x32x16_bf16 v[112:127], v[64:67], v[76:79], v[112:127]
    ds_read_b128 v[88:91], v15 offset:0
    ds_read_b128 v[92:95], v15 offset:4096
    v_mfma_f32_32x32x16_bf16 v[128:143], v[68:71], v[72:75], v[128:143]
    v_mfma_f32_32x32x16_bf16 v[144:159], v[68:71], v[76:79], v[144:159]
    ds_read_b128 v[64:67], v12 offset:0
    ds_read_b128 v[68:71], v12 offset:4096
    ds_read_b128 v[72:75], v13 offset:0
    ds_read_b128 v[76:79], v13 offset:4096
    s_waitcnt lgkmcnt(4)
    v_mfma_f32_32x32x16_bf16 v[96:111], v[80:83], v[88:91], v[96:111]
    v_mfma_f32_32x32x16_bf16 v[112:127], v[80:83], v[92:95], v[112:127]
    v_mfma_f32_32x32x16_bf16 v[128:143], v[84:87], v[88:91], v[128:143]
    s_mov_b32 s39, s37
    s_mov_b32 s37, s38
    s_add_u32 s38, s38, 32768
    s_cmp_ge_u32 s38, 163840
    s_cselect_b32 s38, 0, s38
    s_add_u32 s36, s36, 1
    v_add_u32 v14, s37, v9
    v_add_u32 v15, s37, v11
    v_add_u32 v12, s38, v8
    v_add_u32 v13, s38, v10
    v_mfma_f32_32x32x16_bf16 v[144:159], v[84:87], v[92:95], v[144:159]
    s_waitcnt lgkmcnt(0)
    s_barrier
    v_and_b32 v195, 15, v1
    v_lshlrev_b32 v195, 2, v195
    buffer_load_dword v194, v195, s[32:35], 0 offen sc1
    v_lshlrev_b32 v192, 4, v1
    s_lshl_b32 s52, s42, 13
    s_xor_b32 s53, s52, 32768
    s_add_u32 s52, s52, 12288
    s_add_u32 s53, s53, 12288
    v_add_u32 v193, s53, v192
    v_add_u32 v192, s52, v192
    s_nop 4
    v_mov_b32 v160, v96
    v_mov_b32 v161, v112
    v_mov_b32 v162, v128
    v_mov_b32 v163, v144
    v_fma_f32 v164, v20, v160, v97
    v_fma_f32 v166, v20, v162, v129
    v_fma_f32 v165, v20, v161, v113
    v_fma_f32 v167, v20, v163, v145
    v_fma_f32 v164, -v21, v161, v164
    v_fma_f32 v166, -v21, v163, v166
    v_fma_f32 v161, v21, v160, v165
    v_fma_f32 v163, v21, v162, v167
    v_mov_b32 v160, v164
    v_mov_b32 v162, v166
    v_fma_f32 v164, v20, v160, v98
    v_fma_f32 v166, v20, v162, v130
    v_fma_f32 v165, v20, v161, v114
    v_fma_f32 v167, v20, v163, v146
    v_fma_f32 v164, -v21, v161, v164
    v_fma_f32 v166, -v21, v163, v166
    v_fma_f32 v161, v21, v160, v165
    v_fma_f32 v163, v21, v162, v167
    v_mov_b32 v160, v164
    v_mov_b32 v162, v166
    v_fma_f32 v164, v20, v160, v99
    v_fma_f32 v166, v20, v162, v131
    v_fma_f32 v165, v20, v161, v115
    v_fma_f32 v167, v20, v163, v147
    v_fma_f32 v164, -v21, v161, v164
    v_fma_f32 v166, -v21, v163, v166
    v_fma_f32 v161, v21, v160, v165
    v_fma_f32 v163, v21, v162, v167
    v_mov_b32 v160, v164
    v_mov_b32 v162, v166
    v_fma_f32 v164, v20, v160, v100
    v_fma_f32 v166, v20, v162, v132
    v_fma_f32 v165, v20, v161, v116
    v_fma_f32 v167, v20, v163, v148
    v_fma_f32 v164, -v21, v161, v164
    v_fma_f32 v166, -v21, v163, v166
    v_fma_f32 v161, v21, v160, v165
    v_fma_f32 v163, v21, v162, v167
    v_mov_b32 v160, v164
    v_mov_b32 v162, v166
    v_fma_f32 v164, v20, v160, v101
    v_fma_f32 v166, v20, v162, v133
    v_fma_f32 v165, v20, v161, v117
    v_fma_f32 v167, v20, v163, v149
    v_fma_f32 v164, -v21, v161, v164
    v_fma_f32 v166, -v21, v163, v166
    v_fma_f32 v161, v21, v160, v165
    v_fma_f32 v163, v21, v162, v167
    v_mov_b32 v160, v164
    v_mov_b32 v162, v166
    v_fma_f32 v164, v20, v160, v102
    v_fma_f32 v166, v20, v162, v134
    v_fma_f32 v165, v20, v161, v118
    v_fma_f32 v167, v20, v163, v150
    v_fma_f32 v164, -v21, v161, v164
    v_fma_f32 v166, -v21, v163, v166
    v_fma_f32 v161, v21, v160, v165
    v_fma_f32 v163, v21, v162, v167
    v_mov_b32 v160, v164
    v_mov_b32 v162, v166
    v_fma_f32 v164, v20, v160, v103
    v_fma_f32 v166, v20, v162, v135
    v_fma_f32 v165, v20, v161, v119
    v_fma_f32 v167, v20, v163, v151
    v_fma_f32 v164, -v21, v161, v164
    v_fma_f32 v166, -v21, v163, v166
    v_fma_f32 v161, v21, v160, v165
    v_fma_f32 v163, v21, v162, v167
    v_mov_b32 v160, v164
    v_mov_b32 v162, v166
    v_fma_f32 v164, v20, v160, v104
    v_fma_f32 v166, v20, v162, v136
    v_fma_f32 v165, v20, v161, v120
    v_fma_f32 v167, v20, v163, v152
    v_fma_f32 v164, -v21, v161, v164
    v_fma_f32 v166, -v21, v163, v166
    v_fma_f32 v161, v21, v160, v165
    v_fma_f32 v163, v21, v162, v167
    v_mov_b32 v160, v164
    v_mov_b32 v162, v166
    v_fma_f32 v164, v20, v160, v105
    v_fma_f32 v166, v20, v162, v137
    v_fma_f32 v165, v20, v161, v121
    v_fma_f32 v167, v20, v163, v153
    v_fma_f32 v164, -v21, v161, v164
    v_fma_f32 v166, -v21, v163, v166
    v_fma_f32 v161, v21, v160, v165
    v_fma_f32 v163, v21, v162, v167
    v_mov_b32 v160, v164
    v_mov_b32 v162, v166
    v_fma_f32 v164, v20, v160, v106
    v_fma_f32 v166, v20, v162, v138
    v_fma_f32 v165, v20, v161, v122
    v_fma_f32 v167, v20, v163, v154
    v_fma_f32 v164, -v21, v161, v164
    v_fma_f32 v166, -v21, v163, v166
    v_fma_f32 v161, v21, v160, v165
    v_fma_f32 v163, v21, v162, v167
    v_mov_b32 v160, v164
    v_mov_b32 v162, v166
    v_fma_f32 v164, v20, v160, v107
    v_fma_f32 v166, v20, v162, v139
    v_fma_f32 v165, v20, v161, v123
    v_fma_f32 v167, v20, v163, v155
    v_fma_f32 v164, -v21, v161, v164
    v_fma_f32 v166, -v21, v163, v166
    v_fma_f32 v161, v21, v160, v165
    v_fma_f32 v163, v21, v162, v167
    v_mov_b32 v160, v164
    v_mov_b32 v162, v166
    v_fma_f32 v164, v20, v160, v108
    v_fma_f32 v166, v20, v162, v140
    v_fma_f32 v165, v20, v161, v124
    v_fma_f32 v167, v20, v163, v156
    v_fma_f32 v164, -v21, v161, v164
    v_fma_f32 v166, -v21, v163, v166
    v_fma_f32 v161, v21, v160, v165
    v_fma_f32 v163, v21, v162, v167
    v_mov_b32 v160, v164
    v_mov_b32 v162, v166
    v_fma_f32 v164, v20, v160, v109
    v_fma_f32 v166, v20, v162, v141
    v_fma_f32 v165, v20, v161, v125
    v_fma_f32 v167, v20, v163, v157
    v_fma_f32 v164, -v21, v161, v164
    v_fma_f32 v166, -v21, v163, v166
    v_fma_f32 v161, v21, v160, v165
    v_fma_f32 v163, v21, v162, v167
    v_mov_b32 v160, v164
    v_mov_b32 v162, v166
    v_fma_f32 v164, v20, v160, v110
    v_fma_f32 v166, v20, v162, v142
    v_fma_f32 v165, v20, v161, v126
    v_fma_f32 v167, v20, v163, v158
    v_fma_f32 v164, -v21, v161, v164
    v_fma_f32 v166, -v21, v163, v166
    v_fma_f32 v161, v21, v160, v165
    v_fma_f32 v163, v21, v162, v167
    v_mov_b32 v160, v164
    v_mov_b32 v162, v166
    v_fma_f32 v164, v20, v160, v111
    v_fma_f32 v166, v20, v162, v143
    v_fma_f32 v165, v20, v161, v127
    v_fma_f32 v167, v20, v163, v159
    v_fma_f32 v164, -v21, v161, v164
    v_fma_f32 v166, -v21, v163, v166
    v_fma_f32 v161, v21, v160, v165
    v_fma_f32 v163, v21, v162, v167
    v_mov_b32 v160, v164
    v_mov_b32 v162, v166
    s_lshl_b32 s52, s44, 2
    v_add_u32 v220, s52, v3
    v_lshlrev_b32 v220, 9, v220
    v_lshl_add_u32 v220, v2, 3, v220
    s_lshl_b32 s52, s45, 8
    s_lshl_b32 s53, s43, 12
    s_add_u32 s52, s52, s53
    v_add_u32 v220, s52, v220
    ds_write_b64 v220, v[160:161] offset:0
    ds_write_b64 v220, v[162:163] offset:1024
    s_cmp_eq_u32 s43, 0
    s_cbranch_scc0 K1_w1
    ds_write_b128 v192, v[128:131] offset:0
    ds_write_b128 v192, v[132:135] offset:1024
    ds_write_b128 v192, v[136:139] offset:2048
    ds_write_b128 v192, v[140:143] offset:3072
    ds_write_b128 v192, v[144:147] offset:4096
    ds_write_b128 v192, v[148:151] offset:5120
    ds_write_b128 v192, v[152:155] offset:6144
    ds_write_b128 v192, v[156:159] offset:7168
    s_branch K1_wd
K1_w1:
    ds_write_b128 v192, v[96:99] offset:0
    ds_write_b128 v192, v[100:103] offset:1024
    ds_write_b128 v192, v[104:107] offset:2048
    ds_write_b128 v192, v[108:111] offset:3072
    ds_write_b128 v192, v[112:115] offset:4096
    ds_write_b128 v192, v[116:119] offset:5120
    ds_write_b128 v192, v[120:123] offset:6144
    ds_write_b128 v192, v[124:127] offset:7168
K1_wd:
    s_waitcnt lgkmcnt(0)
    s_barrier
    s_cmp_eq_u32 s42, 0
    s_cbranch_scc1 K1_lb
    ds_read_b128 v[160:163], v193 offset:0
    ds_read_b128 v[164:167], v193 offset:1024
    ds_read_b128 v[168:171], v193 offset:2048
    ds_read_b128 v[172:175], v193 offset:3072
    ds_read_b128 v[176:179], v193 offset:4096
    ds_read_b128 v[180:183], v193 offset:5120
    ds_read_b128 v[184:187], v193 offset:6144
    ds_read_b128 v[188:191], v193 offset:7168
    s_waitcnt lgkmcnt(0)
    s_cmp_eq_u32 s43, 0
    s_cbranch_scc0 K1_a1x
    v_add_f32 v160, v160, v96
    v_add_f32 v161, v161, v97
    v_add_f32 v162, v162, v98
    v_add_f32 v163, v163, v99
    v_add_f32 v164, v164, v100
    v_add_f32 v165, v165, v101
    v_add_f32 v166, v166, v102
    v_add_f32 v167, v167, v103
    v_add_f32 v168, v168, v104
    v_add_f32 v169, v169, v105
    v_add_f32 v170, v170, v106
    v_add_f32 v171, v171, v107
    v_add_f32 v172, v172, v108
    v_add_f32 v173, v173, v109
    v_add_f32 v174, v174, v110
    v_add_f32 v175, v175, v111
    v_add_f32 v176, v176, v112
    v_add_f32 v177, v177, v113
    v_add_f32 v178, v178, v114
    v_add_f32 v179, v179, v115
    v_add_f32 v180, v180, v116
    v_add_f32 v181, v181, v117
    v_add_f32 v182, v182, v118
    v_add_f32 v183, v183, v119
    v_add_f32 v184, v184, v120
    v_add_f32 v185, v185, v121
    v_add_f32 v186, v186, v122
    v_add_f32 v187, v187, v123
    v_add_f32 v188, v188, v124
    v_add_f32 v189, v189, v125
    v_add_f32 v190, v190, v126
    v_add_f32 v191, v191, v127
    s_branch K1_adx
K1_a1x:
    v_add_f32 v160, v160, v128
    v_add_f32 v161, v161, v129
    v_add_f32 v162, v162, v130
    v_add_f32 v163, v163, v131
    v_add_f32 v164, v164, v132
    v_add_f32 v165, v165, v133
    v_add_f32 v166, v166, v134
    v_add_f32 v167, v167, v135
    v_add_f32 v168, v168, v136
    v_add_f32 v169, v169, v137
    v_add_f32 v170, v170, v138
    v_add_f32 v171, v171, v139
    v_add_f32 v172, v172, v140
    v_add_f32 v173, v173, v141
    v_add_f32 v174, v174, v142
    v_add_f32 v175, v175, v143
    v_add_f32 v176, v176, v144
    v_add_f32 v177, v177, v145
    v_add_f32 v178, v178, v146
    v_add_f32 v179, v179, v147
    v_add_f32 v180, v180, v148
    v_add_f32 v181, v181, v149
    v_add_f32 v182, v182, v150
    v_add_f32 v183, v183, v151
    v_add_f32 v184, v184, v152
    v_add_f32 v185, v185, v153
    v_add_f32 v186, v186, v154
    v_add_f32 v187, v187, v155
    v_add_f32 v188, v188, v156
    v_add_f32 v189, v189, v157
    v_add_f32 v190, v190, v158
    v_add_f32 v191, v191, v159
K1_adx:
    s_branch K1_lbdone
K1_lb:
    v_lshlrev_b32 v220, 3, v1
    ds_read_b64 v[200:201], v220 offset:0
    ds_read_b64 v[160:161], v220 offset:4096
    ds_read_b64 v[202:203], v220 offset:512
    ds_read_b64 v[162:163], v220 offset:4608
    ds_read_b64 v[204:205], v220 offset:1024
    ds_read_b64 v[164:165], v220 offset:5120
    ds_read_b64 v[206:207], v220 offset:1536
    ds_read_b64 v[166:167], v220 offset:5632
    ds_read_b64 v[208:209], v220 offset:2048
    ds_read_b64 v[168:169], v220 offset:6144
    ds_read_b64 v[210:211], v220 offset:2560
    ds_read_b64 v[170:171], v220 offset:6656
    ds_read_b64 v[212:213], v220 offset:3072
    ds_read_b64 v[172:173], v220 offset:7168
    ds_read_b64 v[214:215], v220 offset:3584
    ds_read_b64 v[174:175], v220 offset:7680
    s_waitcnt lgkmcnt(0)
    v_add_f32 v200, v200, v160
    v_add_f32 v201, v201, v161
    v_add_f32 v202, v202, v162
    v_add_f32 v203, v203, v163
    v_add_f32 v204, v204, v164
    v_add_f32 v205, v205, v165
    v_add_f32 v206, v206, v166
    v_add_f32 v207, v207, v167
    v_add_f32 v208, v208, v168
    v_add_f32 v209, v209, v169
    v_add_f32 v210, v210, v170
    v_add_f32 v211, v211, v171
    v_add_f32 v212, v212, v172
    v_add_f32 v213, v213, v173
    v_add_f32 v214, v214, v174
    v_add_f32 v215, v215, v175
    v_fma_f32 v198, v26, v200, v202
    v_fma_f32 v199, v26, v201, v203
    v_fma_f32 v198, -v27, v201, v198
    v_fma_f32 v201, v27, v200, v199
    v_mov_b32 v200, v198
    v_fma_f32 v198, v26, v200, v204
    v_fma_f32 v199, v26, v201, v205
    v_fma_f32 v198, -v27, v201, v198
    v_fma_f32 v201, v27, v200, v199
    v_mov_b32 v200, v198
    v_fma_f32 v198, v26, v200, v206
    v_fma_f32 v199, v26, v201, v207
    v_fma_f32 v198, -v27, v201, v198
    v_fma_f32 v201, v27, v200, v199
    v_mov_b32 v200, v198
    v_fma_f32 v198, v26, v200, v208
    v_fma_f32 v199, v26, v201, v209
    v_fma_f32 v198, -v27, v201, v198
    v_fma_f32 v201, v27, v200, v199
    v_mov_b32 v200, v198
    v_fma_f32 v198, v26, v200, v210
    v_fma_f32 v199, v26, v201, v211
    v_fma_f32 v198, -v27, v201, v198
    v_fma_f32 v201, v27, v200, v199
    v_mov_b32 v200, v198
    v_fma_f32 v198, v26, v200, v212
    v_fma_f32 v199, v26, v201, v213
    v_fma_f32 v198, -v27, v201, v198
    v_fma_f32 v201, v27, v200, v199
    v_mov_b32 v200, v198
    v_fma_f32 v198, v26, v200, v214
    v_fma_f32 v199, v26, v201, v215
    v_fma_f32 v198, -v27, v201, v198
    v_fma_f32 v201, v27, v200, v199
    v_mov_b32 v200, v198
    s_lshl_b32 s52, s40, 4
    s_add_u32 s52, s52, s41
    s_lshl_b32 s52, s52, 9
    s_add_u32 s52, s52, 8388608
    v_add_u32 v198, s52, v220
    buffer_store_dwordx2 v[200:201], v198, s[28:31], 0 offen sc1
    ds_read_b128 v[160:163], v193 offset:0
    ds_read_b128 v[164:167], v193 offset:1024
    ds_read_b128 v[168:171], v193 offset:2048
    ds_read_b128 v[172:175], v193 offset:3072
    ds_read_b128 v[176:179], v193 offset:4096
    ds_read_b128 v[180:183], v193 offset:5120
    ds_read_b128 v[184:187], v193 offset:6144
    ds_read_b128 v[188:191], v193 offset:7168
    s_waitcnt lgkmcnt(0)
    s_cmp_eq_u32 s43, 0
    s_cbranch_scc0 K1_a1z
    v_add_f32 v160, v160, v96
    v_add_f32 v161, v161, v97
    v_add_f32 v162, v162, v98
    v_add_f32 v163, v163, v99
    v_add_f32 v164, v164, v100
    v_add_f32 v165, v165, v101
    v_add_f32 v166, v166, v102
    v_add_f32 v167, v167, v103
    v_add_f32 v168, v168, v104
    v_add_f32 v169, v169, v105
    v_add_f32 v170, v170, v106
    v_add_f32 v171, v171, v107
    v_add_f32 v172, v172, v108
    v_add_f32 v173, v173, v109
    v_add_f32 v174, v174, v110
    v_add_f32 v175, v175, v111
    v_add_f32 v176, v176, v112
    v_add_f32 v177, v177, v113
    v_add_f32 v178, v178, v114
    v_add_f32 v179, v179, v115
    v_add_f32 v180, v180, v116
    v_add_f32 v181, v181, v117
    v_add_f32 v182, v182, v118
    v_add_f32 v183, v183, v119
    v_add_f32 v184, v184, v120
    v_add_f32 v185, v185, v121
    v_add_f32 v186, v186, v122
    v_add_f32 v187, v187, v123
    v_add_f32 v188, v188, v124
    v_add_f32 v189, v189, v125
    v_add_f32 v190, v190, v126
    v_add_f32 v191, v191, v127
    s_branch K1_adz
K1_a1z:
    v_add_f32 v160, v160, v128
    v_add_f32 v161, v161, v129
    v_add_f32 v162, v162, v130
    v_add_f32 v163, v163, v131
    v_add_f32 v164, v164, v132
    v_add_f32 v165, v165, v133
    v_add_f32 v166, v166, v134
    v_add_f32 v167, v167, v135
    v_add_f32 v168, v168, v136
    v_add_f32 v169, v169, v137
    v_add_f32 v170, v170, v138
    v_add_f32 v171, v171, v139
    v_add_f32 v172, v172, v140
    v_add_f32 v173, v173, v141
    v_add_f32 v174, v174, v142
    v_add_f32 v175, v175, v143
    v_add_f32 v176, v176, v144
    v_add_f32 v177, v177, v145
    v_add_f32 v178, v178, v146
    v_add_f32 v179, v179, v147
    v_add_f32 v180, v180, v148
    v_add_f32 v181, v181, v149
    v_add_f32 v182, v182, v150
    v_add_f32 v183, v183, v151
    v_add_f32 v184, v184, v152
    v_add_f32 v185, v185, v153
    v_add_f32 v186, v186, v154
    v_add_f32 v187, v187, v155
    v_add_f32 v188, v188, v156
    v_add_f32 v189, v189, v157
    v_add_f32 v190, v190, v158
    v_add_f32 v191, v191, v159
K1_adz:
    v_mov_b32 v216, 0
    v_mov_b32 v217, 0
    s_lshl_b32 s57, 1, s40
    s_sub_u32 s52, s57, 1
    s_mov_b32 s56, 0
    s_waitcnt vmcnt(1)
K1_poll:
    v_readlane_b32 s53, v194, s41
    v_and_b32 v198, s57, v194
    v_cmp_eq_u32 vcc, 0, v198
    s_and_b32 s53, s53, s52
    s_cmp_eq_u32 s53, s52
    s_cbranch_scc0 K1_pollagain
    s_cmp_eq_u64 vcc, 0
    s_cbranch_scc1 K1_polldone
K1_pollagain:
    buffer_load_dword v194, v195, s[32:35], 0 offen sc1
    s_add_u32 s56, s56, 1
    s_waitcnt vmcnt(0)
    s_cmp_lt_u32 s56, 0x200000
    s_cbranch_scc1 K1_poll
K1_polldone:
    s_cmp_eq_u32 s40, 0
    s_cbranch_scc1 K1_nogather
    s_lshl_b32 s52, s41, 9
    s_add_u32 s52, s52, 8388608
    v_add_u32 v194, s52, v220
    s_mov_b32 s56, 0
K1_round:
    s_mov_b32 s53, 0
    buffer_load_dwordx2 v[96:97], v194, s[28:31], s53 offen sc1
    s_mov_b32 s53, 8192
    buffer_load_dwordx2 v[98:99], v194, s[28:31], s53 offen sc1
    s_mov_b32 s53, 16384
    buffer_load_dwordx2 v[100:101], v194, s[28:31], s53 offen sc1
    s_mov_b32 s53, 24576
    buffer_load_dwordx2 v[102:103], v194, s[28:31], s53 offen sc1
    s_mov_b32 s53, 32768
    buffer_load_dwordx2 v[104:105], v194, s[28:31], s53 offen sc1
    s_mov_b32 s53, 40960
    buffer_load_dwordx2 v[106:107], v194, s[28:31], s53 offen sc1
    s_mov_b32 s53, 49152
    buffer_load_dwordx2 v[108:109], v194, s[28:31], s53 offen sc1
    s_mov_b32 s53, 57344
    buffer_load_dwordx2 v[110:111], v194, s[28:31], s53 offen sc1
    s_mov_b32 s53, 65536
    buffer_load_dwordx2 v[112:113], v194, s[28:31], s53 offen sc1
    s_mov_b32 s53, 73728
    buffer_load_dwordx2 v[114:115], v194, s[28:31], s53 offen sc1
    s_mov_b32 s53, 81920
    buffer_load_dwordx2 v[116:117], v194, s[28:31], s53 offen sc1
    s_mov_b32 s53, 90112
    buffer_load_dwordx2 v[118:119], v194, s[28:31], s53 offen sc1
    s_mov_b32 s53, 98304
    buffer_load_dwordx2 v[120:121], v194, s[28:31], s53 offen sc1
    s_mov_b32 s53, 106496
    buffer_load_dwordx2 v[122:123], v194, s[28:31], s53 offen sc1
    s_mov_b32 s53, 114688
    buffer_load_dwordx2 v[124:125], v194, s[28:31], s53 offen sc1
    s_add_u32 s56, s56, 1
    s_cmp_ge_u32 s56, 0x100000
    s_waitcnt vmcnt(0)
    s_cbranch_scc1 K1_allvalid
    s_cmp_le_u32 s40, 0
    s_cbranch_scc1 K1_allvalid
    v_cmp_eq_u32 vcc, -1, v96
    v_cmp_eq_u32 s[54:55], -1, v97
    s_or_b64 s[54:55], s[54:55], vcc
    s_cbranch_scc1 K1_round
    s_cmp_le_u32 s40, 1
    s_cbranch_scc1 K1_allvalid
    v_cmp_eq_u32 vcc, -1, v98
    v_cmp_eq_u32 s[54:55], -1, v99
    s_or_b64 s[54:55], s[54:55], vcc
    s_cbranch_scc1 K1_round
    s_cmp_le_u32 s40, 2
    s_cbranch_scc1 K1_allvalid
    v_cmp_eq_u32 vcc, -1, v100
    v_cmp_eq_u32 s[54:55], -1, v101
    s_or_b64 s[54:55], s[54:55], vcc
    s_cbranch_scc1 K1_round
    s_cmp_le_u32 s40, 3
    s_cbranch_scc1 K1_allvalid
    v_cmp_eq_u32 vcc, -1, v102
    v_cmp_eq_u32 s[54:55], -1, v103
    s_or_b64 s[54:55], s[54:55], vcc
    s_cbranch_scc1 K1_round
    s_cmp_le_u32 s40, 4
    s_cbranch_scc1 K1_allvalid
    v_cmp_eq_u32 vcc, -1, v104
    v_cmp_eq_u32 s[54:55], -1, v105
    s_or_b64 s[54:55], s[54:55], vcc
    s_cbranch_scc1 K1_round
    s_cmp_le_u32 s40, 5
    s_cbranch_scc1 K1_allvalid
    v_cmp_eq_u32 vcc, -1, v106
    v_cmp_eq_u32 s[54:55], -1, v107
    s_or_b64 s[54:55], s[54:55], vcc
    s_cbranch_scc1 K1_round
    s_cmp_le_u32 s40, 6
    s_cbranch_scc1 K1_allvalid
    v_cmp_eq_u32 vcc, -1, v108
    v_cmp_eq_u32 s[54:55], -1, v109
    s_or_b64 s[54:55], s[54:55], vcc
    s_cbranch_scc1 K1_round
    s_cmp_le_u32 s40, 7
    s_cbranch_scc1 K1_allvalid
    v_cmp_eq_u32 vcc, -1, v110
    v_cmp_eq_u32 s[54:55], -1, v111
    s_or_b64 s[54:55], s[54:55], vcc
    s_cbranch_scc1 K1_round
    s_cmp_le_u32 s40, 8
    s_cbranch_scc1 K1_allvalid
    v_cmp_eq_u32 vcc, -1, v112
    v_cmp_eq_u32 s[54:55], -1, v113
    s_or_b64 s[54:55], s[54:55], vcc
    s_cbranch_scc1 K1_round
    s_cmp_le_u32 s40, 9
    s_cbranch_scc1 K1_allvalid
    v_cmp_eq_u32 vcc, -1, v114
    v_cmp_eq_u32 s[54:55], -1, v115
    s_or_b64 s[54:55], s[54:55], vcc
    s_cbranch_scc1 K1_round
    s_cmp_le_u32 s40, 10
    s_cbranch_scc1 K1_allvalid
    v_cmp_eq_u32 vcc, -1, v116
    v_cmp_eq_u32 s[54:55], -1, v117
    s_or_b64 s[54:55], s[54:55], vcc
    s_cbranch_scc1 K1_round
    s_cmp_le_u32 s40, 11
    s_cbranch_scc1 K1_allvalid
    v_cmp_eq_u32 vcc, -1, v118
    v_cmp_eq_u32 s[54:55], -1, v119
    s_or_b64 s[54:55], s[54:55], vcc
    s_cbranch_scc1 K1_round
    s_cmp_le_u32 s40, 12
    s_cbranch_scc1 K1_allvalid
    v_cmp_eq_u32 vcc, -1, v120
    v_cmp_eq_u32 s[54:55], -1, v121
    s_or_b64 s[54:55], s[54:55], vcc
    s_cbranch_scc1 K1_round
    s_cmp_le_u32 s40, 13
    s_cbranch_scc1 K1_allvalid
    v_cmp_eq_u32 vcc, -1, v122
    v_cmp_eq_u32 s[54:55], -1, v123
    s_or_b64 s[54:55], s[54:55], vcc
    s_cbranch_scc1 K1_round
    s_cmp_le_u32 s40, 14
    s_cbranch_scc1 K1_allvalid
    v_cmp_eq_u32 vcc, -1, v124
    v_cmp_eq_u32 s[54:55], -1, v125
    s_or_b64 s[54:55], s[54:55], vcc
    s_cbranch_scc1 K1_round
K1_allvalid:
    s_cmp_le_u32 s40, 0
    s_cbranch_scc1 K1_nogather
    v_fma_f32 v198, v28, v216, v96
    v_fma_f32 v199, v28, v217, v97
    v_fma_f32 v198, -v29, v217, v198
    v_fma_f32 v217, v29, v216, v199
    v_mov_b32 v216, v198
    s_cmp_le_u32 s40, 1
    s_cbranch_scc1 K1_nogather
    v_fma_f32 v198, v28, v216, v98
    v_fma_f32 v199, v28, v217, v99
    v_fma_f32 v198, -v29, v217, v198
    v_fma_f32 v217, v29, v216, v199
    v_mov_b32 v216, v198
    s_cmp_le_u32 s40, 2
    s_cbranch_scc1 K1_nogather
    v_fma_f32 v198, v28, v216, v100
    v_fma_f32 v199, v28, v217, v101
    v_fma_f32 v198, -v29, v217, v198
    v_fma_f32 v217, v29, v216, v199
    v_mov_b32 v216, v198
    s_cmp_le_u32 s40, 3
    s_cbranch_scc1 K1_nogather
    v_fma_f32 v198, v28, v216, v102
    v_fma_f32 v199, v28, v217, v103
    v_fma_f32 v198, -v29, v217, v198
    v_fma_f32 v217, v29, v216, v199
    v_mov_b32 v216, v198
    s_cmp_le_u32 s40, 4
    s_cbranch_scc1 K1_nogather
    v_fma_f32 v198, v28, v216, v104
    v_fma_f32 v199, v28, v217, v105
    v_fma_f32 v198, -v29, v217, v198
    v_fma_f32 v217, v29, v216, v199
    v_mov_b32 v216, v198
    s_cmp_le_u32 s40, 5
    s_cbranch_scc1 K1_nogather
    v_fma_f32 v198, v28, v216, v106
    v_fma_f32 v199, v28, v217, v107
    v_fma_f32 v198, -v29, v217, v198
    v_fma_f32 v217, v29, v216, v199
    v_mov_b32 v216, v198
    s_cmp_le_u32 s40, 6
    s_cbranch_scc1 K1_nogather
    v_fma_f32 v198, v28, v216, v108
    v_fma_f32 v199, v28, v217, v109
    v_fma_f32 v198, -v29, v217, v198
    v_fma_f32 v217, v29, v216, v199
    v_mov_b32 v216, v198
    s_cmp_le_u32 s40, 7
    s_cbranch_scc1 K1_nogather
    v_fma_f32 v198, v28, v216, v110
    v_fma_f32 v199, v28, v217, v111
    v_fma_f32 v198, -v29, v217, v198
    v_fma_f32 v217, v29, v216, v199
    v_mov_b32 v216, v198
    s_cmp_le_u32 s40, 8
    s_cbranch_scc1 K1_nogather
    v_fma_f32 v198, v28, v216, v112
    v_fma_f32 v199, v28, v217, v113
    v_fma_f32 v198, -v29, v217, v198
    v_fma_f32 v217, v29, v216, v199
    v_mov_b32 v216, v198
    s_cmp_le_u32 s40, 9
    s_cbranch_scc1 K1_nogather
    v_fma_f32 v198, v28, v216, v114
    v_fma_f32 v199, v28, v217, v115
    v_fma_f32 v198, -v29, v217, v198
    v_fma_f32 v217, v29, v216, v199
    v_mov_b32 v216, v198
    s_cmp_le_u32 s40, 10
    s_cbranch_scc1 K1_nogather
    v_fma_f32 v198, v28, v216, v116
    v_fma_f32 v199, v28, v217, v117
    v_fma_f32 v198, -v29, v217, v198
    v_fma_f32 v217, v29, v216, v199
    v_mov_b32 v216, v198
    s_cmp_le_u32 s40, 11
    s_cbranch_scc1 K1_nogather
    v_fma_f32 v198, v28, v216, v118
    v_fma_f32 v199, v28, v217, v119
    v_fma_f32 v198, -v29, v217, v198
    v_fma_f32 v217, v29, v216, v199
    v_mov_b32 v216, v198
    s_cmp_le_u32 s40, 12
    s_cbranch_scc1 K1_nogather
    v_fma_f32 v198, v28, v216, v120
    v_fma_f32 v199, v28, v217, v121
    v_fma_f32 v198, -v29, v217, v198
    v_fma_f32 v217, v29, v216, v199
    v_mov_b32 v216, v198
    s_cmp_le_u32 s40, 13
    s_cbranch_scc1 K1_nogather
    v_fma_f32 v198, v28, v216, v122
    v_fma_f32 v199, v28, v217, v123
    v_fma_f32 v198, -v29, v217, v198
    v_fma_f32 v217, v29, v216, v199
    v_mov_b32 v216, v198
    s_cmp_le_u32 s40, 14
    s_cbranch_scc1 K1_nogather
    v_fma_f32 v198, v28, v216, v124
    v_fma_f32 v199, v28, v217, v125
    v_fma_f32 v198, -v29, v217, v198
    v_fma_f32 v217, v29, v216, v199
    v_mov_b32 v216, v198
K1_nogather:
    ds_write_b64 v220, v[216:217] offset:8192
    s_waitcnt lgkmcnt(0)
K1_lbdone:
    s_barrier
    s_lshl_b32 s52, s40, 7
    s_lshl_b32 s53, s42, 4
    s_add_u32 s52, s52, s53
    v_lshrrev_b32 v198, 4, v1
    v_add_u32 v198, s52, v198
    s_lshl_b32 s52, s41, 6
    v_and_b32 v199, 15, v1
    v_lshl_add_u32 v199, v199, 2, s52
    v_lshlrev_b32 v223, 2, v199
    v_lshl_add_u32 v223, v198, 12, v223
    v_lshlrev_b32 v199, 1, v199
    global_load_dwordx2 v[240:241], v199, s[88:89]
    v_lshl_add_u32 v199, v198, 11, v199
    global_load_dwordx2 v[224:225], v199, s[4:5]
    v_add_u32 v199, 8192, v199
    global_load_dwordx2 v[226:227], v199, s[4:5]
    v_add_u32 v199, 8192, v199
    global_load_dwordx2 v[228:229], v199, s[4:5]
    v_add_u32 v199, 8192, v199
    global_load_dwordx2 v[230:231], v199, s[4:5]
    v_lshlrev_b32 v220, 3, v2
    s_lshl_b32 s52, s45, 8
    v_add_u32 v220, s52, v220
    ds_read_b64 v[216:217], v220 offset:8192
    ds_read_b64 v[200:201], v220 offset:0
    ds_read_b64 v[96:97], v220 offset:4096
    ds_read_b64 v[202:203], v220 offset:512
    ds_read_b64 v[98:99], v220 offset:4608
    ds_read_b64 v[204:205], v220 offset:1024
    ds_read_b64 v[100:101], v220 offset:5120
    ds_read_b64 v[206:207], v220 offset:1536
    ds_read_b64 v[102:103], v220 offset:5632
    ds_read_b64 v[208:209], v220 offset:2048
    ds_read_b64 v[104:105], v220 offset:6144
    ds_read_b64 v[210:211], v220 offset:2560
    ds_read_b64 v[106:107], v220 offset:6656
    s_lshl_b32 s52, s46, 9
    v_add_u32 v198, s52, v220
    ds_read_b64 v[218:219], v198 offset:0
    ds_read_b64 v[108:109], v198 offset:4096
    s_waitcnt lgkmcnt(0)
    v_add_f32 v200, v200, v96
    v_add_f32 v201, v201, v97
    v_add_f32 v202, v202, v98
    v_add_f32 v203, v203, v99
    v_add_f32 v204, v204, v100
    v_add_f32 v205, v205, v101
    v_add_f32 v206, v206, v102
    v_add_f32 v207, v207, v103
    v_add_f32 v208, v208, v104
    v_add_f32 v209, v209, v105
    v_add_f32 v210, v210, v106
    v_add_f32 v211, v211, v107
    v_add_f32 v218, v218, v108
    v_add_f32 v219, v219, v109
    s_cmp_le_u32 s46, 0
    s_cbranch_scc1 K1_cdone
    v_fma_f32 v198, v22, v216, v200
    v_fma_f32 v199, v22, v217, v201
    v_fma_f32 v198, -v23, v217, v198
    v_fma_f32 v217, v23, v216, v199
    v_mov_b32 v216, v198
    s_cmp_le_u32 s46, 1
    s_cbranch_scc1 K1_cdone
    v_fma_f32 v198, v22, v216, v202
    v_fma_f32 v199, v22, v217, v203
    v_fma_f32 v198, -v23, v217, v198
    v_fma_f32 v217, v23, v216, v199
    v_mov_b32 v216, v198
    s_cmp_le_u32 s46, 2
    s_cbranch_scc1 K1_cdone
    v_fma_f32 v198, v22, v216, v204
    v_fma_f32 v199, v22, v217, v205
    v_fma_f32 v198, -v23, v217, v198
    v_fma_f32 v217, v23, v216, v199
    v_mov_b32 v216, v198
    s_cmp_le_u32 s46, 3
    s_cbranch_scc1 K1_cdone
    v_fma_f32 v198, v22, v216, v206
    v_fma_f32 v199, v22, v217, v207
    v_fma_f32 v198, -v23, v217, v198
    v_fma_f32 v217, v23, v216, v199
    v_mov_b32 v216, v198
    s_cmp_le_u32 s46, 4
    s_cbranch_scc1 K1_cdone
    v_fma_f32 v198, v22, v216, v208
    v_fma_f32 v199, v22, v217, v209
    v_fma_f32 v198, -v23, v217, v198
    v_fma_f32 v217, v23, v216, v199
    v_mov_b32 v216, v198
    s_cmp_le_u32 s46, 5
    s_cbranch_scc1 K1_cdone
    v_fma_f32 v198, v22, v216, v210
    v_fma_f32 v199, v22, v217, v211
    v_fma_f32 v198, -v23, v217, v198
    v_fma_f32 v217, v23, v216, v199
    v_mov_b32 v216, v198
K1_cdone:
    s_mov_b32 s54, 0
    s_mov_b32 s55, -1
    s_mov_b64 exec, s[54:55]
    v_fma_f32 v198, v22, v216, v218
    v_fma_f32 v199, v22, v217, v219
    v_fma_f32 v198, -v23, v217, v198
    v_fma_f32 v217, v23, v216, v199
    v_mov_b32 v216, v198
    s_mov_b64 exec, -1
    v_fma_f32 v198, v20, v216, v160
    v_fma_f32 v199, v20, v217, v176
    v_fma_f32 v198, -v21, v217, v198
    v_fma_f32 v217, v21, v216, v199
    v_mov_b32 v216, v198
    v_mul_f32 v96, v24, v216
    v_fma_f32 v96, -v25, v217, v96
    v_mul_f32 v112, -v24, v217
    v_fma_f32 v112, -v25, v216, v112
    v_fma_f32 v198, v20, v216, v161
    v_fma_f32 v199, v20, v217, v177
    v_fma_f32 v198, -v21, v217, v198
    v_fma_f32 v217, v21, v216, v199
    v_mov_b32 v216, v198
    v_mul_f32 v97, v24, v216
    v_fma_f32 v97, -v25, v217, v97
    v_mul_f32 v113, -v24, v217
    v_fma_f32 v113, -v25, v216, v113
    v_fma_f32 v198, v20, v216, v162
    v_fma_f32 v199, v20, v217, v178
    v_fma_f32 v198, -v21, v217, v198
    v_fma_f32 v217, v21, v216, v199
    v_mov_b32 v216, v198
    v_mul_f32 v98, v24, v216
    v_fma_f32 v98, -v25, v217, v98
    v_mul_f32 v114, -v24, v217
    v_fma_f32 v114, -v25, v216, v114
    v_fma_f32 v198, v20, v216, v163
    v_fma_f32 v199, v20, v217, v179
    v_fma_f32 v198, -v21, v217, v198
    v_fma_f32 v217, v21, v216, v199
    v_mov_b32 v216, v198
    v_mul_f32 v99, v24, v216
    v_fma_f32 v99, -v25, v217, v99
    v_mul_f32 v115, -v24, v217
    v_fma_f32 v115, -v25, v216, v115
    v_fma_f32 v198, v20, v216, v164
    v_fma_f32 v199, v20, v217, v180
    v_fma_f32 v198, -v21, v217, v198
    v_fma_f32 v217, v21, v216, v199
    v_mov_b32 v216, v198
    v_mul_f32 v100, v24, v216
    v_fma_f32 v100, -v25, v217, v100
    v_mul_f32 v116, -v24, v217
    v_fma_f32 v116, -v25, v216, v116
    v_fma_f32 v198, v20, v216, v165
    v_fma_f32 v199, v20, v217, v181
    v_fma_f32 v198, -v21, v217, v198
    v_fma_f32 v217, v21, v216, v199
    v_mov_b32 v216, v198
    v_mul_f32 v101, v24, v216
    v_fma_f32 v101, -v25, v217, v101
    v_mul_f32 v117, -v24, v217
    v_fma_f32 v117, -v25, v216, v117
    v_fma_f32 v198, v20, v216, v166
    v_fma_f32 v199, v20, v217, v182
    v_fma_f32 v198, -v21, v217, v198
    v_fma_f32 v217, v21, v216, v199
    v_mov_b32 v216, v198
    v_mul_f32 v102, v24, v216
    v_fma_f32 v102, -v25, v217, v102
    v_mul_f32 v118, -v24, v217
    v_fma_f32 v118, -v25, v216, v118
    v_fma_f32 v198, v20, v216, v167
    v_fma_f32 v199, v20, v217, v183
    v_fma_f32 v198, -v21, v217, v198
    v_fma_f32 v217, v21, v216, v199
    v_mov_b32 v216, v198
    v_mul_f32 v103, v24, v216
    v_fma_f32 v103, -v25, v217, v103
    v_mul_f32 v119, -v24, v217
    v_fma_f32 v119, -v25, v216, v119
    v_fma_f32 v198, v20, v216, v168
    v_fma_f32 v199, v20, v217, v184
    v_fma_f32 v198, -v21, v217, v198
    v_fma_f32 v217, v21, v216, v199
    v_mov_b32 v216, v198
    v_mul_f32 v104, v24, v216
    v_fma_f32 v104, -v25, v217, v104
    v_mul_f32 v120, -v24, v217
    v_fma_f32 v120, -v25, v216, v120
    v_fma_f32 v198, v20, v216, v169
    v_fma_f32 v199, v20, v217, v185
    v_fma_f32 v198, -v21, v217, v198
    v_fma_f32 v217, v21, v216, v199
    v_mov_b32 v216, v198
    v_mul_f32 v105, v24, v216
    v_fma_f32 v105, -v25, v217, v105
    v_mul_f32 v121, -v24, v217
    v_fma_f32 v121, -v25, v216, v121
    v_fma_f32 v198, v20, v216, v170
    v_fma_f32 v199, v20, v217, v186
    v_fma_f32 v198, -v21, v217, v198
    v_fma_f32 v217, v21, v216, v199
    v_mov_b32 v216, v198
    v_mul_f32 v106, v24, v216
    v_fma_f32 v106, -v25, v217, v106
    v_mul_f32 v122, -v24, v217
    v_fma_f32 v122, -v25, v216, v122
    v_fma_f32 v198, v20, v216, v171
    v_fma_f32 v199, v20, v217, v187
    v_fma_f32 v198, -v21, v217, v198
    v_fma_f32 v217, v21, v216, v199
    v_mov_b32 v216, v198
    v_mul_f32 v107, v24, v216
    v_fma_f32 v107, -v25, v217, v107
    v_mul_f32 v123, -v24, v217
    v_fma_f32 v123, -v25, v216, v123
    v_fma_f32 v198, v20, v216, v172
    v_fma_f32 v199, v20, v217, v188
    v_fma_f32 v198, -v21, v217, v198
    v_fma_f32 v217, v21, v216, v199
    v_mov_b32 v216, v198
    v_mul_f32 v108, v24, v216
    v_fma_f32 v108, -v25, v217, v108
    v_mul_f32 v124, -v24, v217
    v_fma_f32 v124, -v25, v216, v124
    v_fma_f32 v198, v20, v216, v173
    v_fma_f32 v199, v20, v217, v189
    v_fma_f32 v198, -v21, v217, v198
    v_fma_f32 v217, v21, v216, v199
    v_mov_b32 v216, v198
    v_mul_f32 v109, v24, v216
    v_fma_f32 v109, -v25, v217, v109
    v_mul_f32 v125, -v24, v217
    v_fma_f32 v125, -v25, v216, v125
    v_fma_f32 v198, v20, v216, v174
    v_fma_f32 v199, v20, v217, v190
    v_fma_f32 v198, -v21, v217, v198
    v_fma_f32 v217, v21, v216, v199
    v_mov_b32 v216, v198
    v_mul_f32 v110, v24, v216
    v_fma_f32 v110, -v25, v217, v110
    v_mul_f32 v126, -v24, v217
    v_fma_f32 v126, -v25, v216, v126
    v_fma_f32 v198, v20, v216, v175
    v_fma_f32 v199, v20, v217, v191
    v_fma_f32 v198, -v21, v217, v198
    v_fma_f32 v217, v21, v216, v199
    v_mov_b32 v216, v198
    v_mul_f32 v111, v24, v216
    v_fma_f32 v111, -v25, v217, v111
    v_mul_f32 v127, -v24, v217
    v_fma_f32 v127, -v25, v216, v127
    v_cvt_pk_bf16_f32 v128, v96, v97
    v_cvt_pk_bf16_f32 v129, v98, v99
    v_cvt_pk_bf16_f32 v130, v100, v101
    v_cvt_pk_bf16_f32 v131, v102, v103
    v_cvt_pk_bf16_f32 v132, v104, v105
    v_cvt_pk_bf16_f32 v133, v106, v107
    v_cvt_pk_bf16_f32 v134, v108, v109
    v_cvt_pk_bf16_f32 v135, v110, v111
    v_cvt_pk_bf16_f32 v136, v112, v113
    v_cvt_pk_bf16_f32 v137, v114, v115
    v_cvt_pk_bf16_f32 v138, v116, v117
    v_cvt_pk_bf16_f32 v139, v118, v119
    v_cvt_pk_bf16_f32 v140, v120, v121
    v_cvt_pk_bf16_f32 v141, v122, v123
    v_cvt_pk_bf16_f32 v142, v124, v125
    v_cvt_pk_bf16_f32 v143, v126, v127
    s_lshl_b32 s52, s42, 12
    s_add_u32 s52, s52, 77824
    v_lshlrev_b32 v220, 6, v2
    v_lshl_add_u32 v220, v3, 5, v220
    v_add_u32 v220, s52, v220
    ds_write_b128 v220, v[128:131]
    ds_write_b128 v220, v[132:135] offset:16
    ds_write_b128 v220, v[136:139] offset:2048
    ds_write_b128 v220, v[140:143] offset:2064
    v_lshrrev_b32 v198, 4, v1
    v_lshrrev_b32 v199, 2, v1
    v_and_b32 v199, 3, v199
    v_lshl_add_u32 v199, v198, 3, v199
    v_lshlrev_b32 v199, 6, v199
    v_and_b32 v220, 3, v1
    v_lshl_add_u32 v199, v220, 3, v199
    v_add_u32 v199, s52, v199
    v_and_b32 v220, 15, v1
    s_lshl_b32 s52, s40, 7
    s_lshl_b32 s53, s46, 4
    s_add_u32 s52, s52, s53
    v_add_u32 v220, s52, v220
    v_lshlrev_b32 v220, 12, v220
    v_lshl_add_u32 v220, v198, 4, v220
    s_lshl_b32 s52, s41, 7
    s_lshl_b32 s53, s45, 6
    s_add_u32 s52, s52, s53
    v_add_u32 v220, s52, v220
    v_add_u32 v198, 65536, v220
    s_waitcnt lgkmcnt(0)
    ds_read_b64_tr_b16 v[160:161], v199 offset:0
    ds_read_b64_tr_b16 v[162:163], v199 offset:256
    ds_read_b64_tr_b16 v[164:165], v199 offset:32
    ds_read_b64_tr_b16 v[166:167], v199 offset:288
    ds_read_b64_tr_b16 v[168:169], v199 offset:2048
    ds_read_b64_tr_b16 v[170:171], v199 offset:2304
    ds_read_b64_tr_b16 v[172:173], v199 offset:2080
    ds_read_b64_tr_b16 v[174:175], v199 offset:2336
    s_waitcnt lgkmcnt(0)
    buffer_store_dwordx4 v[160:163], v220, s[28:31], 0 offen offset:0 sc1
    buffer_store_dwordx4 v[164:167], v198, s[28:31], 0 offen offset:0 sc1
    buffer_store_dwordx4 v[168:171], v220, s[28:31], 0 offen offset:2048 sc1
    buffer_store_dwordx4 v[172:175], v198, s[28:31], 0 offen offset:2048 sc1
    v_mov_b32 v198, s58
    v_mov_b32 v199, 1
    s_and_b32 s44, s42, 3
    v_lshrrev_b32 v52, 3, v1
    v_and_b32 v52, 3, v52
    v_lshl_add_u32 v52, v3, 4, v52
    v_lshrrev_b32 v53, 4, v1
    v_and_b32 v54, 7, v1
    v_xor_b32 v53, v53, v54
    s_lshl_b32 s52, s43, 5
    s_lshl_b32 s53, s44, 2
    s_add_u32 s52, s52, s53
    s_lshl_b32 s53, s41, 6
    s_add_u32 s52, s52, s53
    v_add_u32 v4, s52, v52
    v_lshlrev_b32 v4, 11, v4
    s_and_b32 s53, s42, 1
    s_lshl_b32 s53, s53, 2
    v_xor_b32 v54, s53, v53
    v_lshl_add_u32 v4, v54, 4, v4
    s_lshl_b32 s52, s40, 7
    s_lshl_b32 s53, s42, 4
    s_add_u32 s52, s52, s53
    s_add_u32 s52, s52, 0
    v_lshrrev_b32 v5, 3, v1
    v_add_u32 v5, s52, v5
    v_lshlrev_b32 v5, 12, v5
    v_xor_b32 v54, 0, v53
    v_lshl_add_u32 v5, v54, 4, v5
    s_lshl_b32 s52, s40, 7
    s_lshl_b32 s53, s42, 4
    s_add_u32 s52, s52, s53
    s_add_u32 s52, s52, 8
    v_lshrrev_b32 v6, 3, v1
    v_add_u32 v6, s52, v6
    v_lshlrev_b32 v6, 12, v6
    v_xor_b32 v54, 4, v53
    v_lshl_add_u32 v6, v54, 4, v6
    s_lshl_b32 s48, s42, 10
    s_lshl_b32 s49, s42, 11
    s_add_u32 s49, s49, 8192
    s_mov_b32 s20, s84
    s_and_b32 s21, s85, 0xffff
    s_mov_b32 s22, 2097152
    s_mov_b32 s23, 0x00020000
    s_mov_b32 s24, s90
    s_and_b32 s25, s91, 0xffff
    s_mov_b32 s26, 8388608
    s_mov_b32 s27, 0x00020000
    v_lshrrev_b32 v52, 1, v2
    v_and_b32 v52, 7, v52
    v_xor_b32 v52, v52, v3
    s_lshl_b32 s52, s43, 2
    s_add_u32 s53, s52, 0
    v_xor_b32 v53, s53, v52
    v_lshlrev_b32 v53, 4, v53
    v_lshl_add_u32 v8, v2, 7, v53
    s_lshl_b32 s53, s44, 12
    s_add_u32 s53, s53, 8192
    v_add_u32 v10, s53, v8
    s_add_u32 s53, s52, 2
    v_xor_b32 v53, s53, v52
    v_lshlrev_b32 v53, 4, v53
    v_lshl_add_u32 v9, v2, 7, v53
    s_lshl_b32 s53, s44, 12
    s_add_u32 s53, s53, 8192
    v_add_u32 v11, s53, v9
    v_mov_b32 v96, 0
    v_mov_b32 v97, 0
    v_mov_b32 v98, 0
    v_mov_b32 v99, 0
    v_mov_b32 v100, 0
    v_mov_b32 v101, 0
    v_mov_b32 v102, 0
    v_mov_b32 v103, 0
    v_mov_b32 v104, 0
    v_mov_b32 v105, 0
    v_mov_b32 v106, 0
    v_mov_b32 v107, 0
    v_mov_b32 v108, 0
    v_mov_b32 v109, 0
    v_mov_b32 v110, 0
    v_mov_b32 v111, 0
    v_mov_b32 v112, 0
    v_mov_b32 v113, 0
    v_mov_b32 v114, 0
    v_mov_b32 v115, 0
    v_mov_b32 v116, 0
    v_mov_b32 v117, 0
    v_mov_b32 v118, 0
    v_mov_b32 v119, 0
    v_mov_b32 v120, 0
    v_mov_b32 v121, 0
    v_mov_b32 v122, 0
    v_mov_b32 v123, 0
    v_mov_b32 v124, 0
    v_mov_b32 v125, 0
    v_mov_b32 v126, 0
    v_mov_b32 v127, 0
    v_mov_b32 v144, v223
    s_waitcnt vmcnt(4)
    v_lshlrev_b32 v54, 16, v240
    v_and_b32 v55, 0xffff0000, v240
    v_lshlrev_b32 v56, 16, v241
    v_and_b32 v57, 0xffff0000, v241
    v_lshlrev_b32 v52, 16, v224
    v_and_b32 v53, 0xffff0000, v224
    v_mul_f32 v52, v52, v54
    v_mul_f32 v53, v53, v55
    v_cvt_pk_bf16_f32 v52, v52, v53
    v_lshlrev_b32 v232, 16, v52
    v_and_b32 v233, 0xffff0000, v52
    v_lshlrev_b32 v52, 16, v225
    v_and_b32 v53, 0xffff0000, v225
    v_mul_f32 v52, v52, v56
    v_mul_f32 v53, v53, v57
    v_cvt_pk_bf16_f32 v52, v52, v53
    v_lshlrev_b32 v234, 16, v52
    v_and_b32 v235, 0xffff0000, v52
    v_lshlrev_b32 v52, 16, v226
    v_and_b32 v53, 0xffff0000, v226
    v_mul_f32 v52, v52, v54
    v_mul_f32 v53, v53, v55
    v_cvt_pk_bf16_f32 v52, v52, v53
    v_lshlrev_b32 v236, 16, v52
    v_and_b32 v237, 0xffff0000, v52
    v_lshlrev_b32 v52, 16, v227
    v_and_b32 v53, 0xffff0000, v227
    v_mul_f32 v52, v52, v56
    v_mul_f32 v53, v53, v57
    v_cvt_pk_bf16_f32 v52, v52, v53
    v_lshlrev_b32 v238, 16, v52
    v_and_b32 v239, 0xffff0000, v52
    v_lshlrev_b32 v52, 16, v228
    v_and_b32 v53, 0xffff0000, v228
    v_mul_f32 v52, v52, v54
    v_mul_f32 v53, v53, v55
    v_cvt_pk_bf16_f32 v52, v52, v53
    v_lshlrev_b32 v240, 16, v52
    v_and_b32 v241, 0xffff0000, v52
    v_lshlrev_b32 v52, 16, v229
    v_and_b32 v53, 0xffff0000, v229
    v_mul_f32 v52, v52, v56
    v_mul_f32 v53, v53, v57
    v_cvt_pk_bf16_f32 v52, v52, v53
    v_lshlrev_b32 v242, 16, v52
    v_and_b32 v243, 0xffff0000, v52
    v_lshlrev_b32 v52, 16, v230
    v_and_b32 v53, 0xffff0000, v230
    v_mul_f32 v52, v52, v54
    v_mul_f32 v53, v53, v55
    v_cvt_pk_bf16_f32 v52, v52, v53
    v_lshlrev_b32 v244, 16, v52
    v_and_b32 v245, 0xffff0000, v52
    v_lshlrev_b32 v52, 16, v231
    v_and_b32 v53, 0xffff0000, v231
    v_mul_f32 v52, v52, v56
    v_mul_f32 v53, v53, v57
    v_cvt_pk_bf16_f32 v52, v52, v53
    v_lshlrev_b32 v246, 16, v52
    v_and_b32 v247, 0xffff0000, v52
    s_waitcnt vmcnt(0)
    s_mov_b64 exec, 1
    buffer_store_dword v199, v198, s[28:31], 0 offen sc1
    s_mov_b64 exec, -1
    s_barrier
    s_add_u32 s45, s41, 0
    s_and_b32 s45, s45, 15
    s_lshl_b32 s45, s45, 7
    s_add_u32 s47, s45, 0
    s_mov_b32 s20, s84
    s_and_b32 s21, s85, 0xffff
    s_add_u32 m0, s48, 0
    s_nop 0
    buffer_load_dwordx4 v4, s[20:23], s45 offen lds
    s_add_u32 m0, s49, 0
    s_nop 0
    buffer_load_dwordx4 v5, s[28:31], s47 offen sc1 lds
    s_add_u32 m0, s49, 1024
    s_nop 0
    buffer_load_dwordx4 v6, s[28:31], s47 offen sc1 lds
    s_add_u32 s45, s41, 0
    s_and_b32 s45, s45, 15
    s_lshl_b32 s45, s45, 7
    s_add_u32 s47, s45, 2048
    s_mov_b32 s20, s86
    s_and_b32 s21, s87, 0xffff
    s_add_u32 m0, s48, 24576
    s_nop 0
    buffer_load_dwordx4 v4, s[20:23], s45 offen lds
    s_add_u32 m0, s49, 24576
    s_nop 0
    buffer_load_dwordx4 v5, s[28:31], s47 offen sc1 lds
    s_add_u32 m0, s49, 25600
    s_nop 0
    buffer_load_dwordx4 v6, s[28:31], s47 offen sc1 lds
    s_add_u32 s45, s41, 1
    s_and_b32 s45, s45, 15
    s_lshl_b32 s45, s45, 7
    s_add_u32 s47, s45, 0
    s_mov_b32 s20, s84
    s_and_b32 s21, s85, 0xffff
    s_add_u32 m0, s48, 49152
    s_nop 0
    buffer_load_dwordx4 v4, s[20:23], s45 offen lds
    s_add_u32 s45, s41, 1
    s_and_b32 s45, s45, 15
    s_lshl_b32 s45, s45, 7
    s_add_u32 s47, s45, 2048
    s_mov_b32 s20, s86
    s_and_b32 s21, s87, 0xffff
    s_add_u32 m0, s48, 73728
    s_nop 0
    buffer_load_dwordx4 v4, s[20:23], s45 offen lds
    s_add_u32 s45, s41, 2
    s_and_b32 s45, s45, 15
    s_lshl_b32 s45, s45, 7
    s_add_u32 s47, s45, 0
    s_mov_b32 s20, s84
    s_and_b32 s21, s85, 0xffff
    s_add_u32 m0, s48, 98304
    s_nop 0
    buffer_load_dwordx4 v4, s[20:23], s45 offen lds
    s_cmp_lg_u32 s42, 0
    s_cbranch_scc1 K2_polldone
    v_lshlrev_b32 v56, 3, v1
    s_lshl_b32 s52, s40, 9
    s_add_u32 s52, s52, 8519680
    v_add_u32 v57, s52, v56
    s_mov_b32 s56, 0
K2_poll:
    buffer_load_dwordx2 v[58:59], v57, s[28:31], 0 offen sc1
    s_add_u32 s56, s56, 1
    s_waitcnt vmcnt(0)
    v_cmp_ne_u32 vcc, 1, v58
    v_cmp_ne_u32 s[54:55], 1, v59
    s_or_b64 s[54:55], s[54:55], vcc
    s_cbranch_scc0 K2_polldone
    s_cmp_lt_u32 s56, 0x200000
    s_cbranch_scc1 K2_poll
K2_polldone:
    s_barrier
    s_add_u32 s45, s41, 1
    s_and_b32 s45, s45, 15
    s_lshl_b32 s45, s45, 7
    s_add_u32 s47, s45, 0
    s_mov_b32 s20, s84
    s_and_b32 s21, s85, 0xffff
    s_add_u32 m0, s49, 49152
    s_nop 0
    buffer_load_dwordx4 v5, s[28:31], s47 offen sc1 lds
    s_add_u32 m0, s49, 50176
    s_nop 0
    buffer_load_dwordx4 v6, s[28:31], s47 offen sc1 lds
    s_add_u32 s45, s41, 1
    s_and_b32 s45, s45, 15
    s_lshl_b32 s45, s45, 7
    s_add_u32 s47, s45, 2048
    s_mov_b32 s20, s86
    s_and_b32 s21, s87, 0xffff
    s_add_u32 m0, s49, 73728
    s_nop 0
    buffer_load_dwordx4 v5, s[28:31], s47 offen sc1 lds
    s_add_u32 m0, s49, 74752
    s_nop 0
    buffer_load_dwordx4 v6, s[28:31], s47 offen sc1 lds
    s_add_u32 s45, s41, 2
    s_and_b32 s45, s45, 15
    s_lshl_b32 s45, s45, 7
    s_add_u32 s47, s45, 0
    s_mov_b32 s20, s84
    s_and_b32 s21, s85, 0xffff
    s_add_u32 m0, s49, 98304
    s_nop 0
    buffer_load_dwordx4 v5, s[28:31], s47 offen sc1 lds
    s_add_u32 m0, s49, 99328
    s_nop 0
    buffer_load_dwordx4 v6, s[28:31], s47 offen sc1 lds
    s_waitcnt vmcnt(6)
    s_barrier
    ds_read_b128 v[64:67], v8 offset:0
    ds_read_b128 v[68:71], v8 offset:4096
    ds_read_b128 v[72:75], v10
    s_mov_b32 s36, 0
    s_mov_b32 s37, 0
    s_mov_b32 s38, 24576
    s_mov_b32 s39, 122880
    v_add_u32 v14, s37, v9
    v_add_u32 v15, s37, v11
    v_add_u32 v12, s38, v8
    v_add_u32 v13, s38, v10
    s_add_u32 s45, s41, 2
    s_and_b32 s45, s45, 15
    s_lshl_b32 s45, s45, 7
    s_add_u32 s47, s45, 2048
    s_mov_b32 s20, s86
    s_and_b32 s21, s87, 0xffff
    s_waitcnt lgkmcnt(0)
    v_mfma_f32_32x32x16_bf16 v[96:111], v[64:67], v[72:75], v[96:111]
    ds_read_b128 v[76:79], v14 offset:0
    ds_read_b128 v[80:83], v14 offset:4096
    ds_read_b128 v[84:87], v15
    s_add_u32 s61, s48, s39
    s_add_u32 m0, s61, 0
    s_nop 0
    buffer_load_dwordx4 v4, s[20:23], s45 offen lds
    v_mfma_f32_32x32x16_bf16 v[112:127], v[68:71], v[72:75], v[112:127]
    ds_read_b128 v[64:67], v12 offset:0
    ds_read_b128 v[68:71], v12 offset:4096
    ds_read_b128 v[72:75], v13
    s_add_u32 s61, s49, s39
    s_add_u32 m0, s61, 0
    s_nop 0
    buffer_load_dwordx4 v5, s[28:31], s47 offen sc1 lds
    s_waitcnt lgkmcnt(3)
    v_mfma_f32_32x32x16_bf16 v[96:111], v[76:79], v[84:87], v[96:111]
    s_add_u32 s61, s49, s39
    s_add_u32 m0, s61, 1024
    s_nop 0
    buffer_load_dwordx4 v6, s[28:31], s47 offen sc1 lds
    s_mov_b32 s39, s37
    s_mov_b32 s37, s38
    s_add_u32 s38, s38, 24576
    s_cmp_ge_u32 s38, 147456
    s_cselect_b32 s38, 0, s38
    s_add_u32 s36, s36, 1
    v_add_u32 v14, s37, v9
    v_add_u32 v15, s37, v11
    v_add_u32 v12, s38, v8
    v_add_u32 v13, s38, v10
    s_add_u32 s52, s36, 5
    s_lshr_b32 s53, s52, 1
    s_add_u32 s45, s41, s53
    s_and_b32 s45, s45, 15
    s_lshl_b32 s45, s45, 7
    s_and_b32 s52, s52, 1
    s_lshl_b32 s53, s52, 11
    s_add_u32 s47, s45, s53
    s_cmp_eq_u32 s52, 0
    s_cselect_b32 s20, s84, s86
    s_cselect_b32 s53, s85, s87
    s_and_b32 s21, s53, 0xffff
    v_mfma_f32_32x32x16_bf16 v[112:127], v[80:83], v[84:87], v[112:127]
    s_waitcnt vmcnt(7) lgkmcnt(0)
    s_barrier
    v_mfma_f32_32x32x16_bf16 v[96:111], v[64:67], v[72:75], v[96:111]
    ds_read_b128 v[76:79], v14 offset:0
    ds_read_b128 v[80:83], v14 offset:4096
    ds_read_b128 v[84:87], v15
    s_add_u32 s61, s48, s39
    s_add_u32 m0, s61, 0
    s_nop 0
    buffer_load_dwordx4 v4, s[20:23], s45 offen lds
    v_mfma_f32_32x32x16_bf16 v[112:127], v[68:71], v[72:75], v[112:127]
    ds_read_b128 v[64:67], v12 offset:0
    ds_read_b128 v[68:71], v12 offset:4096
    ds_read_b128 v[72:75], v13
    s_add_u32 s61, s49, s39
    s_add_u32 m0, s61, 0
    s_nop 0
    buffer_load_dwordx4 v5, s[28:31], s47 offen sc1 lds
    s_waitcnt lgkmcnt(3)
    v_mfma_f32_32x32x16_bf16 v[96:111], v[76:79], v[84:87], v[96:111]
    s_add_u32 s61, s49, s39
    s_add_u32 m0, s61, 1024
    s_nop 0
    buffer_load_dwordx4 v6, s[28:31], s47 offen sc1 lds
    s_mov_b32 s39, s37
    s_mov_b32 s37, s38
    s_add_u32 s38, s38, 24576
    s_cmp_ge_u32 s38, 147456
    s_cselect_b32 s38, 0, s38
    s_add_u32 s36, s36, 1
    v_add_u32 v14, s37, v9
    v_add_u32 v15, s37, v11
    v_add_u32 v12, s38, v8
    v_add_u32 v13, s38, v10
    s_add_u32 s52, s36, 5
    s_lshr_b32 s53, s52, 1
    s_add_u32 s45, s41, s53
    s_and_b32 s45, s45, 15
    s_lshl_b32 s45, s45, 7
    s_and_b32 s52, s52, 1
    s_lshl_b32 s53, s52, 11
    s_add_u32 s47, s45, s53
    s_cmp_eq_u32 s52, 0
    s_cselect_b32 s20, s84, s86
    s_cselect_b32 s53, s85, s87
    s_and_b32 s21, s53, 0xffff
    v_mfma_f32_32x32x16_bf16 v[112:127], v[80:83], v[84:87], v[112:127]
    s_waitcnt vmcnt(8) lgkmcnt(0)
    s_barrier
K2_loop:
    v_mfma_f32_32x32x16_bf16 v[96:111], v[64:67], v[72:75], v[96:111]
    ds_read_b128 v[76:79], v14 offset:0
    ds_read_b128 v[80:83], v14 offset:4096
    ds_read_b128 v[84:87], v15
    s_add_u32 s61, s48, s39
    s_add_u32 m0, s61, 0
    s_nop 0
    buffer_load_dwordx4 v4, s[20:23], s45 offen lds
    v_mfma_f32_32x32x16_bf16 v[112:127], v[68:71], v[72:75], v[112:127]
    ds_read_b128 v[64:67], v12 offset:0
    ds_read_b128 v[68:71], v12 offset:4096
    ds_read_b128 v[72:75], v13
    s_add_u32 s61, s49, s39
    s_add_u32 m0, s61, 0
    s_nop 0
    buffer_load_dwordx4 v5, s[28:31], s47 offen sc1 lds
    s_waitcnt lgkmcnt(3)
    v_mfma_f32_32x32x16_bf16 v[96:111], v[76:79], v[84:87], v[96:111]
    s_add_u32 s61, s49, s39
    s_add_u32 m0, s61, 1024
    s_nop 0
    buffer_load_dwordx4 v6, s[28:31], s47 offen sc1 lds
    s_mov_b32 s39, s37
    s_mov_b32 s37, s38
    s_add_u32 s38, s38, 24576
    s_cmp_ge_u32 s38, 147456
    s_cselect_b32 s38, 0, s38
    s_add_u32 s36, s36, 1
    v_add_u32 v14, s37, v9
    v_add_u32 v15, s37, v11
    v_add_u32 v12, s38, v8
    v_add_u32 v13, s38, v10
    s_add_u32 s52, s36, 5
    s_lshr_b32 s53, s52, 1
    s_add_u32 s45, s41, s53
    s_and_b32 s45, s45, 15
    s_lshl_b32 s45, s45, 7
    s_and_b32 s52, s52, 1
    s_lshl_b32 s53, s52, 11
    s_add_u32 s47, s45, s53
    s_cmp_eq_u32 s52, 0
    s_cselect_b32 s20, s84, s86
    s_cselect_b32 s53, s85, s87
    s_and_b32 s21, s53, 0xffff
    v_mfma_f32_32x32x16_bf16 v[112:127], v[80:83], v[84:87], v[112:127]
    s_waitcnt vmcnt(9) lgkmcnt(0)
    s_cmp_lt_u32 s36, 27
    s_barrier
    s_cbranch_scc1 K2_loop
    v_mfma_f32_32x32x16_bf16 v[96:111], v[64:67], v[72:75], v[96:111]
    ds_read_b128 v[76:79], v14 offset:0
    ds_read_b128 v[80:83], v14 offset:4096
    ds_read_b128 v[84:87], v15
    v_mfma_f32_32x32x16_bf16 v[112:127], v[68:71], v[72:75], v[112:127]
    ds_read_b128 v[64:67], v12 offset:0
    ds_read_b128 v[68:71], v12 offset:4096
    ds_read_b128 v[72:75], v13
    s_waitcnt lgkmcnt(3)
    v_mfma_f32_32x32x16_bf16 v[96:111], v[76:79], v[84:87], v[96:111]
    s_mov_b32 s39, s37
    s_mov_b32 s37, s38
    s_add_u32 s38, s38, 24576
    s_cmp_ge_u32 s38, 147456
    s_cselect_b32 s38, 0, s38
    s_add_u32 s36, s36, 1
    v_add_u32 v14, s37, v9
    v_add_u32 v15, s37, v11
    v_add_u32 v12, s38, v8
    v_add_u32 v13, s38, v10
    v_mfma_f32_32x32x16_bf16 v[112:127], v[80:83], v[84:87], v[112:127]
    s_waitcnt vmcnt(6) lgkmcnt(0)
    s_barrier
    v_mfma_f32_32x32x16_bf16 v[96:111], v[64:67], v[72:75], v[96:111]
    ds_read_b128 v[76:79], v14 offset:0
    ds_read_b128 v[80:83], v14 offset:4096
    ds_read_b128 v[84:87], v15
    v_mfma_f32_32x32x16_bf16 v[112:127], v[68:71], v[72:75], v[112:127]
    ds_read_b128 v[64:67], v12 offset:0
    ds_read_b128 v[68:71], v12 offset:4096
    ds_read_b128 v[72:75], v13
    s_waitcnt lgkmcnt(3)
    v_mfma_f32_32x32x16_bf16 v[96:111], v[76:79], v[84:87], v[96:111]
    s_mov_b32 s39, s37
    s_mov_b32 s37, s38
    s_add_u32 s38, s38, 24576
    s_cmp_ge_u32 s38, 147456
    s_cselect_b32 s38, 0, s38
    s_add_u32 s36, s36, 1
    v_add_u32 v14, s37, v9
    v_add_u32 v15, s37, v11
    v_add_u32 v12, s38, v8
    v_add_u32 v13, s38, v10
    v_mfma_f32_32x32x16_bf16 v[112:127], v[80:83], v[84:87], v[112:127]
    s_waitcnt vmcnt(3) lgkmcnt(0)
    s_barrier
    v_mfma_f32_32x32x16_bf16 v[96:111], v[64:67], v[72:75], v[96:111]
    ds_read_b128 v[76:79], v14 offset:0
    ds_read_b128 v[80:83], v14 offset:4096
    ds_read_b128 v[84:87], v15
    v_mfma_f32_32x32x16_bf16 v[112:127], v[68:71], v[72:75], v[112:127]
    ds_read_b128 v[64:67], v12 offset:0
    ds_read_b128 v[68:71], v12 offset:4096
    ds_read_b128 v[72:75], v13
    s_waitcnt lgkmcnt(3)
    v_mfma_f32_32x32x16_bf16 v[96:111], v[76:79], v[84:87], v[96:111]
    s_mov_b32 s39, s37
    s_mov_b32 s37, s38
    s_add_u32 s38, s38, 24576
    s_cmp_ge_u32 s38, 147456
    s_cselect_b32 s38, 0, s38
    s_add_u32 s36, s36, 1
    v_add_u32 v14, s37, v9
    v_add_u32 v15, s37, v11
    v_add_u32 v12, s38, v8
    v_add_u32 v13, s38, v10
    v_mfma_f32_32x32x16_bf16 v[112:127], v[80:83], v[84:87], v[112:127]
    s_waitcnt vmcnt(0) lgkmcnt(0)
    s_barrier
    v_mfma_f32_32x32x16_bf16 v[96:111], v[64:67], v[72:75], v[96:111]
    ds_read_b128 v[76:79], v14 offset:0
    ds_read_b128 v[80:83], v14 offset:4096
    ds_read_b128 v[84:87], v15
    v_mfma_f32_32x32x16_bf16 v[112:127], v[68:71], v[72:75], v[112:127]
    ds_read_b128 v[64:67], v12 offset:0
    ds_read_b128 v[68:71], v12 offset:4096
    ds_read_b128 v[72:75], v13
    s_waitcnt lgkmcnt(3)
    v_mfma_f32_32x32x16_bf16 v[96:111], v[76:79], v[84:87], v[96:111]
    s_mov_b32 s39, s37
    s_mov_b32 s37, s38
    s_add_u32 s38, s38, 24576
    s_cmp_ge_u32 s38, 147456
    s_cselect_b32 s38, 0, s38
    s_add_u32 s36, s36, 1
    v_add_u32 v14, s37, v9
    v_add_u32 v15, s37, v11
    v_add_u32 v12, s38, v8
    v_add_u32 v13, s38, v10
    v_mfma_f32_32x32x16_bf16 v[112:127], v[80:83], v[84:87], v[112:127]
    s_waitcnt lgkmcnt(0)
    s_barrier
    v_mfma_f32_32x32x16_bf16 v[96:111], v[64:67], v[72:75], v[96:111]
    ds_read_b128 v[76:79], v14 offset:0
    ds_read_b128 v[80:83], v14 offset:4096
    ds_read_b128 v[84:87], v15
    v_mfma_f32_32x32x16_bf16 v[112:127], v[68:71], v[72:75], v[112:127]
    ds_read_b128 v[64:67], v12 offset:0
    ds_read_b128 v[68:71], v12 offset:4096
    ds_read_b128 v[72:75], v13
    s_waitcnt lgkmcnt(3)
    v_mfma_f32_32x32x16_bf16 v[96:111], v[76:79], v[84:87], v[96:111]
    s_mov_b32 s39, s37
    s_mov_b32 s37, s38
    s_add_u32 s38, s38, 24576
    s_cmp_ge_u32 s38, 147456
    s_cselect_b32 s38, 0, s38
    s_add_u32 s36, s36, 1
    v_add_u32 v14, s37, v9
    v_add_u32 v15, s37, v11
    v_add_u32 v12, s38, v8
    v_add_u32 v13, s38, v10
    v_mfma_f32_32x32x16_bf16 v[112:127], v[80:83], v[84:87], v[112:127]
    s_waitcnt lgkmcnt(0)
    s_barrier
    s_lshl_b32 s52, s44, 5
    v_add_u32 v52, s52, v2
    v_mul_u32_u24 v52, 272, v52
    v_lshl_add_u32 v52, v3, 6, v52
    s_mul_i32 s52, s43, 34816
    v_add_u32 v52, s52, v52
    v_lshrrev_b32 v53, 4, v1
    s_lshl_b32 s52, s42, 4
    v_add_u32 v53, s52, v53
    v_mul_u32_u24 v53, 272, v53
    v_and_b32 v54, 15, v1
    v_lshl_add_u32 v53, v54, 4, v53
    s_nop 4
    ds_write_b128 v52, v[96:99] offset:0
    ds_write_b128 v52, v[100:103] offset:16
    ds_write_b128 v52, v[104:107] offset:32
    ds_write_b128 v52, v[108:111] offset:48
    ds_write_b128 v52, v[112:115] offset:128
    ds_write_b128 v52, v[116:119] offset:144
    ds_write_b128 v52, v[120:123] offset:160
    ds_write_b128 v52, v[124:127] offset:176
    s_waitcnt lgkmcnt(0)
    s_barrier
    ds_read_b128 v[128:131], v53 offset:0
    ds_read_b128 v[64:67], v53 offset:34816
    ds_read_b128 v[132:135], v53 offset:1088
    ds_read_b128 v[68:71], v53 offset:35904
    ds_read_b128 v[136:139], v53 offset:2176
    ds_read_b128 v[72:75], v53 offset:36992
    ds_read_b128 v[140:143], v53 offset:3264
    ds_read_b128 v[76:79], v53 offset:38080
    s_waitcnt lgkmcnt(6)
    v_add_f32 v128, v128, v64
    v_add_f32 v128, v128, v232
    v_add_f32 v129, v129, v65
    v_add_f32 v129, v129, v233
    v_add_f32 v130, v130, v66
    v_add_f32 v130, v130, v234
    v_add_f32 v131, v131, v67
    v_add_f32 v131, v131, v235
    buffer_store_dwordx4 v[128:131], v144, s[24:27], 0 offen
    v_add_u32 v144, 16384, v144
    s_waitcnt lgkmcnt(4)
    v_add_f32 v132, v132, v68
    v_add_f32 v132, v132, v236
    v_add_f32 v133, v133, v69
    v_add_f32 v133, v133, v237
    v_add_f32 v134, v134, v70
    v_add_f32 v134, v134, v238
    v_add_f32 v135, v135, v71
    v_add_f32 v135, v135, v239
    buffer_store_dwordx4 v[132:135], v144, s[24:27], 0 offen
    v_add_u32 v144, 16384, v144
    s_waitcnt lgkmcnt(2)
    v_add_f32 v136, v136, v72
    v_add_f32 v136, v136, v240
    v_add_f32 v137, v137, v73
    v_add_f32 v137, v137, v241
    v_add_f32 v138, v138, v74
    v_add_f32 v138, v138, v242
    v_add_f32 v139, v139, v75
    v_add_f32 v139, v139, v243
    buffer_store_dwordx4 v[136:139], v144, s[24:27], 0 offen
    v_add_u32 v144, 16384, v144
    s_waitcnt lgkmcnt(0)
    v_add_f32 v140, v140, v76
    v_add_f32 v140, v140, v244
    v_add_f32 v141, v141, v77
    v_add_f32 v141, v141, v245
    v_add_f32 v142, v142, v78
    v_add_f32 v142, v142, v246
    v_add_f32 v143, v143, v79
    v_add_f32 v143, v143, v247
    buffer_store_dwordx4 v[140:143], v144, s[24:27], 0 offen
KF_done:
    s_endpgm
.section .rodata,"a"
.p2align 6
.amdhsa_kernel standalone__ssm_conv_s5__prompt_kernel
  .amdhsa_next_free_vgpr 256
  .amdhsa_next_free_sgpr 96
  .amdhsa_accum_offset 256
  .amdhsa_group_segment_fixed_size 0
  .amdhsa_kernarg_size 96
  .amdhsa_user_sgpr_count 2
  .amdhsa_user_sgpr_kernarg_segment_ptr 1
  .amdhsa_system_sgpr_workgroup_id_x 1
  .amdhsa_float_denorm_mode_32 3
.end_amdhsa_kernel
```
